```python
import torch

def _softmax(x, axis=-1):
    return torch.softmax(x, dim=axis)
def _gelu(x):
    return torch.nn.functional.gelu(x, approximate="tanh")
def _silu(x):
    return torch.nn.functional.silu(x)
def _sigmoid(x):
    return torch.sigmoid(x)
def _layernorm(x, axis=-1, eps=1e-5):
    m = x.mean(dim=axis, keepdim=True)
    v = x.var(dim=axis, keepdim=True, unbiased=False)
    return (x - m) / torch.sqrt(v + eps)
def _scatter_add(tgt, idx, src, axis=0):
    return tgt.clone().index_add_(axis, idx, src)
def _segment_sum(src, seg, n):
    out = torch.zeros((n,) + src.shape[1:], dtype=src.dtype)
    return out.index_add_(0, seg, src)
def _pad(x, pw):
    flat = tuple(v for pair in reversed(pw) for v in pair)
    return torch.nn.functional.pad(x, flat)

kernel_name = 'concat_heads__linear_kernel_hedgehog__grouped_kv_mqa__prompt'

def setup_inputs():

    _w = (lambda a: (lambda t: t.to(torch.bfloat16) if t.is_floating_point() else t)(torch.as_tensor(a)))
    def _A_setup():
        B, S, D, H = 1, 2048, 1024, 32
        Dh = D // H
        return {
            "x": _w((lambda *s: torch.randn(*s, dtype=torch.bfloat16) * 0.4)(B, S, D)),
            "wqkv": _w((lambda *s: torch.randn(*s, dtype=torch.bfloat16) * 0.4)(D, 3 * D)),
            "w_phi": _w((lambda *s: torch.randn(*s, dtype=torch.bfloat16) * 0.4)(H, Dh, Dh) * (Dh ** -0.5)),
            "wo": _w((lambda *s: torch.randn(*s, dtype=torch.bfloat16) * 0.05)(D, D)),
        }
    _A_in = _A_setup()

    def _B_setup():
        B, S, D, H = 1, 2048, 1024, 32
        Dh = D // H
        return {
            "x": _w((lambda *s: torch.randn(*s, dtype=torch.bfloat16) * 0.05)(B, S, D)),
            "wq": _w((lambda *s: torch.randn(*s, dtype=torch.bfloat16) * 0.8)(D, H * Dh)),
            "wk": _w((lambda *s: torch.randn(*s, dtype=torch.bfloat16) * 0.8)(D, Dh)),
            "wv": _w((lambda *s: torch.randn(*s, dtype=torch.bfloat16) * 0.1)(D, Dh)),
            "wo": _w((lambda *s: torch.randn(*s, dtype=torch.bfloat16) * 0.1)(H * Dh, D)),
        }
    _B_in = _B_setup()

    return {
        "A_x": _A_in["x"],
        "A_wqkv": _A_in["wqkv"],
        "A_w_phi": _A_in["w_phi"],
        "A_wo": _A_in["wo"],
        "B_x": _B_in["x"],
        "B_wq": _B_in["wq"],
        "B_wk": _B_in["wk"],
        "B_wv": _B_in["wv"],
        "B_wo": _B_in["wo"],
    }

def reference(A_x, A_wqkv, A_w_phi, A_wo, B_x, B_wq, B_wk, B_wv, B_wo):
    def _A_ref(x, wqkv, w_phi, wo):
        B, S, D = x.shape
        H = 32; Dh = D // H
        qkv = (lambda x, *d: x.permute(*d))((x @ wqkv).reshape(B, S, 3, H, Dh), 2, 0, 3, 1, 4)
        q, k, v = qkv[0], qkv[1], qkv[2]
        pq = torch.einsum("bhsd,hdf->bhsf", q, w_phi)
        pk = torch.einsum("bhsd,hdf->bhsf", k, w_phi)
        phi_q = torch.concatenate([_softmax(pq, axis=-1), _softmax(-pq, axis=-1)], axis=-1)
        phi_k = torch.concatenate([_softmax(pk, axis=-1), _softmax(-pk, axis=-1)], axis=-1)
        kv = torch.einsum("bhsf,bhsd->bhfd", phi_k, v)
        z  = torch.einsum("bhsf->bhf", phi_k)
        num = torch.einsum("bhqf,bhfd->bhqd", phi_q, kv)
        den = torch.einsum("bhqf,bhf->bhq", phi_q, z)[..., None] + 1e-6
        o = num / den
        return (lambda x, *d: x.permute(*d))(o, 0, 2, 1, 3).reshape(B, S, D) @ wo

    def _B_ref(x, wq, wk, wv, wo):
        B, S, D = x.shape
        H = 32
        Dh = D // H
        q = (lambda x, *d: x.permute(*d))((x @ wq).reshape(B, S, H, Dh), 0, 2, 1, 3)
        k = x @ wk
        v = x @ wv
        scores = torch.einsum("bhqd,bkd->bhqk", q, k) * (Dh ** -0.5)
        p = _softmax(scores, axis=-1)
        o = torch.einsum("bhqk,bkd->bhqd", p, v)
        return (lambda x, *d: x.permute(*d))(o, 0, 2, 1, 3).reshape(B, S, H * Dh) @ wo

    a = _A_ref(A_x, A_wqkv, A_w_phi, A_wo)
    b = _B_ref(B_x, B_wq, B_wk, B_wv, B_wo)
    return torch.concatenate([a, b], axis=-1)
```

```asm
; @launch kernel=k1_kernel grid=(256,1,1) block=(512,1,1) lds=159744
; @launch kernel=k2_kernel grid=(256,1,1) block=(512,1,1) lds=163840
.amdgcn_target "amdgcn-amd-amdhsa--gfx950"
.text
.globl k1_kernel
.p2align 8
.type k1_kernel,@function
k1_kernel:
    s_cmp_ge_u32 s2, 256
    s_cbranch_scc1 K1_end
    s_load_dwordx16 s[44:59], s[0:1], 0
    s_load_dwordx2 s[60:61], s[0:1], 88
    v_lshrrev_b32 v1, 6, v0
    v_and_b32 v0, 63, v0
    v_readfirstlane_b32 s34, v1
    s_and_b32 s3, s2, 7
    s_lshr_b32 s36, s2, 3
    s_and_b32 s35, s3, 1
    s_lshl_b32 s35, s35, 3
    s_and_b32 s37, s36, 7
    s_add_u32 s35, s35, s37
    s_lshr_b32 s40, s3, 1
    s_lshl_b32 s40, s40, 2
    s_lshr_b32 s37, s36, 3
    s_add_u32 s40, s40, s37
    s_mov_b32 s36, 0x87625410
    s_mov_b32 s37, 0xfedcba93
    s_lshl_b32 s40, s40, 2
    s_lshr_b64 s[36:37], s[36:37], s40
    s_and_b32 s40, s36, 15
    v_bfe_u32 v12, v0, 2, 2
    v_and_b32 v14, 3, v0
    v_lshrrev_b32 v2, 2, v0
    s_lshl_b32 s3, s35, 7
    s_lshl_b32 s37, s34, 4
    s_add_u32 s3, s3, s37
    v_add_u32 v2, s3, v2
    v_lshlrev_b32 v2, 11, v2
    v_bfe_u32 v15, v0, 4, 2
    v_xor_b32 v15, v15, v14
    v_lshl_add_u32 v2, v15, 4, v2
    v_lshrrev_b32 v3, 4, v0
    v_lshlrev_b32 v3, 6, v3
    v_lshl_add_u32 v3, v14, 4, v3
    s_lshl_b32 s3, s34, 2
    v_add_u32 v1, s3, v12
    s_mul_i32 s31, s34, 3328
    s_add_u32 s41, s31, 159744
    s_mov_b32 s28, 0
    s_mov_b32 s29, 0
    s_mov_b32 s30, 0
    s_cmp_lt_u32 s40, 4
    s_cbranch_scc1 K1_T0
    s_cmp_lt_u32 s40, 12
    s_cbranch_scc1 K1_T1
    s_cmp_lt_u32 s40, 14
    s_cbranch_scc1 K1_T2
    s_branch K1_T3
K1_T0:
    s_lshl_b32 s42, s40, 9
    s_add_u32 s37, s42, 256
    v_mul_u32_u24 v1, 6144, v1
    v_add_u32 v3, v3, v1
    s_waitcnt lgkmcnt(0)
    s_mov_b32 s8, s44
    s_and_b32 s9, s45, 0xffff
    s_mov_b32 s10, 4194304
    s_mov_b32 s11, 0x00020000
    s_add_u32 s12, s46, s42
    s_addc_u32 s13, s47, 0
    s_sub_u32 s12, s12, 1024
    s_subb_u32 s13, s13, 0
    s_and_b32 s13, s13, 0xffff
    s_sub_u32 s14, 6292480, s42
    s_mov_b32 s15, 0x00020000
    s_add_u32 s16, s46, s37
    s_addc_u32 s17, s47, 0
    s_sub_u32 s16, s16, 2048
    s_subb_u32 s17, s17, 0
    s_and_b32 s17, s17, 0xffff
    s_sub_u32 s18, 6293504, s37
    s_mov_b32 s19, 0x00020000
    s_mov_b32 m0, s31
    s_add_u32 s31, s31, 26624
    buffer_load_dwordx4 v2, s[8:11], s28 offen lds
    buffer_load_dwordx4 v3, s[12:15], s29 offen offset:1024 lds
    buffer_load_dwordx4 v3, s[16:19], s29 offen offset:2048 lds
    s_add_u32 s28, s28, 64
    s_add_u32 s29, s29, 196608
    s_mov_b32 m0, s31
    s_add_u32 s31, s31, 26624
    buffer_load_dwordx4 v2, s[8:11], s28 offen lds
    buffer_load_dwordx4 v3, s[12:15], s29 offen offset:1024 lds
    buffer_load_dwordx4 v3, s[16:19], s29 offen offset:2048 lds
    s_add_u32 s28, s28, 64
    s_add_u32 s29, s29, 196608
    v_lshrrev_b32 v13, 5, v0
    s_mov_b32 s20, s48
    s_and_b32 s21, s49, 0xffff
    s_mov_b32 s22, 65536
    s_mov_b32 s23, 0x00020000
    s_and_b32 s39, s34, 3
    s_lshl_b32 s3, s40, 3
    s_add_u32 s36, s3, s39
    s_lshl_b32 s30, s36, 11
    v_lshlrev_b32 v4, 4, v0
    s_mov_b32 s62, 0x3fb8aa3b
    s_mov_b32 s63, 0x3fb8aa3b
    s_lshr_b32 s38, s34, 2
    s_and_b32 s39, s34, 3
    v_and_b32 v10, 15, v0
    v_lshlrev_b32 v5, 6, v10
    v_bfe_u32 v11, v0, 4, 1
    v_mul_u32_u24 v15, 3328, v11
    v_add_u32 v5, v5, v15
    s_mul_i32 s3, s38, 13312
    v_add_u32 v5, s3, v5
    v_xor_b32 v7, v13, v12
    v_xor_b32 v15, 2, v7
    v_lshl_add_u32 v6, v15, 4, v5
    v_lshl_add_u32 v5, v7, 4, v5
    v_mul_u32_u24 v7, 6656, v13
    v_lshl_add_u32 v7, v12, 6, v7
    v_lshl_add_u32 v7, v11, 5, v7
    v_lshl_add_u32 v7, v14, 3, v7
    s_lshl_b32 s3, s39, 8
    s_add_u32 s3, s3, 1024
    v_add_u32 v7, s3, v7
    s_mov_b32 s32, 0
    s_mov_b32 s43, 0
    s_mov_b32 s65, 0
    s_mov_b32 s64, 4294834176
    v_mov_b32 v16, 0
    v_mov_b32 v17, 0
    v_mov_b32 v18, 0
    v_mov_b32 v19, 0
    v_mov_b32 v20, 0
    v_mov_b32 v21, 0
    v_mov_b32 v22, 0
    v_mov_b32 v23, 0
    v_mov_b32 v24, 0
    v_mov_b32 v25, 0
    v_mov_b32 v26, 0
    v_mov_b32 v27, 0
    v_mov_b32 v28, 0
    v_mov_b32 v29, 0
    v_mov_b32 v30, 0
    v_mov_b32 v31, 0
    v_mov_b32 v32, 0
    v_mov_b32 v33, 0
    v_mov_b32 v34, 0
    v_mov_b32 v35, 0
    v_mov_b32 v36, 0
    v_mov_b32 v37, 0
    v_mov_b32 v38, 0
    v_mov_b32 v39, 0
    v_mov_b32 v40, 0
    v_mov_b32 v41, 0
    v_mov_b32 v42, 0
    v_mov_b32 v43, 0
    v_mov_b32 v44, 0
    v_mov_b32 v45, 0
    v_mov_b32 v46, 0
    v_mov_b32 v47, 0
    v_mov_b32 v48, 0
    v_mov_b32 v49, 0
    v_mov_b32 v50, 0
    v_mov_b32 v51, 0
    v_mov_b32 v52, 0
    v_mov_b32 v53, 0
    v_mov_b32 v54, 0
    v_mov_b32 v55, 0
    v_mov_b32 v56, 0
    v_mov_b32 v57, 0
    v_mov_b32 v58, 0
    v_mov_b32 v59, 0
    v_mov_b32 v60, 0
    v_mov_b32 v61, 0
    v_mov_b32 v62, 0
    v_mov_b32 v63, 0
    v_mov_b32 v64, 0
    v_mov_b32 v65, 0
    v_mov_b32 v66, 0
    v_mov_b32 v67, 0
    v_mov_b32 v68, 0
    v_mov_b32 v69, 0
    v_mov_b32 v70, 0
    v_mov_b32 v71, 0
    v_mov_b32 v72, 0
    v_mov_b32 v73, 0
    v_mov_b32 v74, 0
    v_mov_b32 v75, 0
    v_mov_b32 v76, 0
    v_mov_b32 v77, 0
    v_mov_b32 v78, 0
    v_mov_b32 v79, 0
    s_mov_b32 s24, s60
    s_and_b32 s25, s61, 0xffff
    s_mov_b32 s26, 27267072
    s_mov_b32 s27, 0x00020000
    s_mov_b32 m0, s31
    s_add_u32 s31, s31, 26624
    buffer_load_dwordx4 v2, s[8:11], s28 offen lds
    buffer_load_dwordx4 v3, s[12:15], s29 offen offset:1024 lds
    buffer_load_dwordx4 v3, s[16:19], s29 offen offset:2048 lds
    s_add_u32 s28, s28, 64
    s_add_u32 s29, s29, 196608
    s_mov_b32 m0, s31
    s_add_u32 s31, s31, 26624
    buffer_load_dwordx4 v2, s[8:11], s28 offen lds
    buffer_load_dwordx4 v3, s[12:15], s29 offen offset:1024 lds
    buffer_load_dwordx4 v3, s[16:19], s29 offen offset:2048 lds
    s_add_u32 s28, s28, 64
    s_add_u32 s29, s29, 196608
    s_mov_b32 m0, s31
    s_add_u32 s31, s31, 26624
    buffer_load_dwordx4 v2, s[8:11], s28 offen lds
    buffer_load_dwordx4 v3, s[12:15], s29 offen offset:1024 lds
    buffer_load_dwordx4 v3, s[16:19], s29 offen offset:2048 lds
    s_add_u32 s28, s28, 64
    s_add_u32 s29, s29, 196608
    s_lshr_b32 s67, s34, 1
    s_add_u32 s69, s67, 2
    s_lshl_b32 s67, s67, 2
    s_sub_i32 s67, s67, 0
    s_max_i32 s67, s67, 0
    v_lshrrev_b32 v188, 1, v0
    v_lshlrev_b32 v188, 11, v188
    v_and_b32 v189, 1, v0
    v_lshl_add_u32 v188, v189, 7, v188
    s_lshr_b32 s3, s2, 6
    s_and_b32 s3, s3, 3
    s_lshl_b32 s3, s3, 5
    s_lshl_b32 s66, s35, 7
    s_add_u32 s3, s3, s66
    s_lshl_b32 s66, s3, 11
    s_lshl_b32 s3, s69, 8
    s_add_u32 s66, s66, s3
    s_mov_b32 s68, 1024
    s_bitcmp0_b32 s34, 0
    s_cbranch_scc1 rpf_1
    v_lshrrev_b32 v188, 2, v0
    v_mul_u32_u24 v188, 6144, v188
    v_lshl_add_u32 v188, v189, 7, v188
    v_bfe_u32 v189, v0, 1, 1
    v_mul_u32_u24 v189, 256, v189
    v_add_u32 v188, v188, v189
    s_and_b32 s3, s35, 7
    s_lshl_b32 s3, s3, 4
    s_lshl_b32 s66, s69, 7
    s_add_u32 s3, s3, s66
    s_mul_i32 s66, s3, 6144
    s_mov_b32 s68, 3145728
rpf_1:
    s_waitcnt vmcnt(12)
    s_barrier
    ds_read_b128 v[80:83], v5 offset:0
    ds_read_b64_tr_b16 v[88:89], v7 offset:0
    ds_read_b64_tr_b16 v[90:91], v7 offset:3328
    ds_read_b64_tr_b16 v[92:93], v7 offset:1024
    ds_read_b64_tr_b16 v[94:95], v7 offset:4352
    ds_read_b128 v[84:87], v5 offset:6656
.p2align 6
K1_T0_loop:
    s_waitcnt lgkmcnt(0)
    v_mfma_f32_32x32x16_bf16 v[16:31], v[88:91], v[80:83], v[16:31]
    ds_read_b128 v[96:99], v6 offset:0
    ds_read_b64_tr_b16 v[104:105], v7 offset:13312
    v_mfma_f32_32x32x16_bf16 v[32:47], v[92:95], v[80:83], v[32:47]
    ds_read_b64_tr_b16 v[106:107], v7 offset:16640
    ds_read_b64_tr_b16 v[108:109], v7 offset:14336
    v_mfma_f32_32x32x16_bf16 v[48:63], v[88:91], v[84:87], v[48:63]
    ds_read_b64_tr_b16 v[110:111], v7 offset:17664
    ds_read_b128 v[100:103], v6 offset:6656
    s_cmp_ge_u32 s32, 28
    v_mfma_f32_32x32x16_bf16 v[64:79], v[92:95], v[84:87], v[64:79]
    s_cbranch_scc1 K1_T0_loop_tw
    s_waitcnt vmcnt(9)
K1_T0_loop_back:
    s_barrier
    s_add_u32 s43, s43, 1
    s_cmp_eq_u32 s43, 6
    s_cselect_b32 s33, s64, 26624
    s_cselect_b32 s43, 0, s43
    s_waitcnt lgkmcnt(0)
    v_mfma_f32_32x32x16_bf16 v[16:31], v[104:107], v[96:99], v[16:31]
    v_add_u32 v5, s33, v5
    v_add_u32 v7, s33, v7
    ds_read_b128 v[80:83], v5 offset:0
    ds_read_b64_tr_b16 v[88:89], v7 offset:0
    v_mfma_f32_32x32x16_bf16 v[32:47], v[108:111], v[96:99], v[32:47]
    ds_read_b64_tr_b16 v[90:91], v7 offset:3328
    ds_read_b64_tr_b16 v[92:93], v7 offset:1024
    ds_read_b64_tr_b16 v[94:95], v7 offset:4352
    ds_read_b128 v[84:87], v5 offset:6656
    s_cmp_ge_u32 s32, 27
    v_mfma_f32_32x32x16_bf16 v[48:63], v[104:107], v[100:103], v[48:63]
    v_add_u32 v6, s33, v6
    s_cbranch_scc1 K1_T0_loop_pd
    s_mov_b32 m0, s31
    s_add_u32 s31, s31, 26624
    buffer_load_dwordx4 v2, s[8:11], s28 offen lds
    buffer_load_dwordx4 v3, s[12:15], s29 offen offset:1024 lds
    buffer_load_dwordx4 v3, s[16:19], s29 offen offset:2048 lds
    s_add_u32 s28, s28, 64
    s_add_u32 s29, s29, 196608
    s_cmp_ge_u32 s31, s41
    s_cselect_b32 s3, 159744, 0
    s_sub_u32 s31, s31, s3
    s_cmp_eq_u32 s32, s67
    s_cbranch_scc1 K1_T0_loop_rpf
K1_T0_loop_nodma:
    s_add_u32 s32, s32, 1
    s_cmp_lt_u32 s32, 32
    v_mfma_f32_32x32x16_bf16 v[64:79], v[108:111], v[100:103], v[64:79]
    s_cbranch_scc1 K1_T0_loop
    s_branch K1_T0_loop_done
K1_T0_loop_tw:
    s_cmp_eq_u32 s32, 28
    s_cbranch_scc1 K1_T0_loop_tw2
    s_cmp_eq_u32 s32, 29
    s_cbranch_scc1 K1_T0_loop_tw1
    s_waitcnt vmcnt(4)
    s_cmp_eq_u32 s32, 30
    s_cbranch_scc1 K1_T0_loop_back
    v_lshlrev_b32 v8, 8, v13
    v_lshl_add_u32 v8, v12, 6, v8
    v_lshl_add_u32 v8, v11, 5, v8
    v_lshl_add_u32 v8, v14, 3, v8
    v_add_u32 v8, s65, v8
    s_waitcnt vmcnt(0)
    ds_read_b64_tr_b16 v[156:157], v8 offset:0
    ds_read_b64_tr_b16 v[158:159], v8 offset:512
    ds_read_b64_tr_b16 v[160:161], v8 offset:1024
    ds_read_b64_tr_b16 v[162:163], v8 offset:1536
    ds_read_b64_tr_b16 v[164:165], v8 offset:26624
    ds_read_b64_tr_b16 v[166:167], v8 offset:27136
    ds_read_b64_tr_b16 v[168:169], v8 offset:27648
    ds_read_b64_tr_b16 v[170:171], v8 offset:28160
    s_waitcnt lgkmcnt(0)
    s_branch K1_T0_loop_back
K1_T0_loop_tw2:
    s_waitcnt vmcnt(8)
    s_branch K1_T0_loop_back
K1_T0_loop_tw1:
    s_waitcnt vmcnt(7)
    s_branch K1_T0_loop_back
K1_T0_loop_pd:
    s_cmp_ge_u32 s32, 29
    s_cbranch_scc1 K1_T0_loop_nodma
    s_mov_b32 m0, s31
    s_cmp_eq_u32 s32, 27
    s_cselect_b32 s65, s31, s65
    s_add_u32 s31, s31, 26624
    buffer_load_dwordx4 v4, s[20:23], s30 offen lds
    buffer_load_dwordx4 v4, s[20:23], s30 offen offset:1024 lds
    s_add_u32 s30, s30, 8192
    s_branch K1_T0_loop_nodma
K1_T0_loop_rpf:
    s_bitcmp0_b32 s34, 0
    s_cbranch_scc1 K1_T0_loop_rpfx
    buffer_load_dword v190, v188, s[12:15], s66 offen offset:1024
    s_branch K1_T0_loop_rpfc
K1_T0_loop_rpfx:
    buffer_load_dword v190, v188, s[8:11], s66 offen
K1_T0_loop_rpfc:
    s_add_u32 s66, s66, s68
    s_add_u32 s69, s69, 4
    s_lshr_b32 s67, s34, 1
    s_lshl_b32 s67, s67, 2
    s_add_u32 s67, s67, 16
    s_cmp_ge_u32 s69, 8
    s_cselect_b32 s67, 99, s67
    s_branch K1_T0_loop_nodma
K1_T0_loop_done:
    s_nop 15
    s_waitcnt lgkmcnt(0)
    v_mov_b32 v9, 0x42700000
    s_lshl_b32 s3, s36, 18
    s_lshl_b32 s37, s35, 14
    s_add_u32 s3, s3, s37
    s_lshl_b32 s37, s38, 13
    s_add_u32 s3, s3, s37
    s_add_u32 s37, s3, 1048576
    v_lshlrev_b32 v1, 4, v0
    v_add_u32 v2, 4096, v1
    v_cvt_pk_bf16_f32 v16, v16, v17
    v_cvt_pk_bf16_f32 v17, v18, v19
    v_cvt_pk_bf16_f32 v18, v20, v21
    v_cvt_pk_bf16_f32 v19, v22, v23
    v_cvt_pk_bf16_f32 v20, v24, v25
    v_cvt_pk_bf16_f32 v21, v26, v27
    v_cvt_pk_bf16_f32 v22, v28, v29
    v_cvt_pk_bf16_f32 v23, v30, v31
    v_mfma_f32_32x32x16_bf16 v[80:95], v[156:159], v[16:19], 0
    s_nop 0
    v_mfma_f32_32x32x16_bf16 v[80:95], v[160:163], v[20:23], v[80:95]
    v_cvt_pk_bf16_f32 v48, v48, v49
    v_cvt_pk_bf16_f32 v49, v50, v51
    v_cvt_pk_bf16_f32 v50, v52, v53
    v_cvt_pk_bf16_f32 v51, v54, v55
    v_cvt_pk_bf16_f32 v52, v56, v57
    v_cvt_pk_bf16_f32 v53, v58, v59
    v_cvt_pk_bf16_f32 v54, v60, v61
    v_cvt_pk_bf16_f32 v55, v62, v63
    v_mfma_f32_32x32x16_bf16 v[96:111], v[156:159], v[48:51], 0
    s_nop 0
    v_mfma_f32_32x32x16_bf16 v[96:111], v[160:163], v[52:55], v[96:111]
    v_cvt_pk_bf16_f32 v32, v32, v33
    v_cvt_pk_bf16_f32 v33, v34, v35
    v_cvt_pk_bf16_f32 v34, v36, v37
    v_cvt_pk_bf16_f32 v35, v38, v39
    v_cvt_pk_bf16_f32 v36, v40, v41
    v_cvt_pk_bf16_f32 v37, v42, v43
    v_cvt_pk_bf16_f32 v38, v44, v45
    v_cvt_pk_bf16_f32 v39, v46, v47
    v_mfma_f32_32x32x16_bf16 v[112:127], v[164:167], v[32:35], 0
    s_nop 0
    v_mfma_f32_32x32x16_bf16 v[112:127], v[168:171], v[36:39], v[112:127]
    v_cvt_pk_bf16_f32 v64, v64, v65
    v_cvt_pk_bf16_f32 v65, v66, v67
    v_cvt_pk_bf16_f32 v66, v68, v69
    v_cvt_pk_bf16_f32 v67, v70, v71
    v_cvt_pk_bf16_f32 v68, v72, v73
    v_cvt_pk_bf16_f32 v69, v74, v75
    v_cvt_pk_bf16_f32 v70, v76, v77
    v_cvt_pk_bf16_f32 v71, v78, v79
    v_mfma_f32_32x32x16_bf16 v[128:143], v[164:167], v[64:67], 0
    s_nop 0
    v_mfma_f32_32x32x16_bf16 v[128:143], v[168:171], v[68:71], v[128:143]
    v_pk_mul_f32 v[80:81], v[80:81], s[62:63]
    v_pk_mul_f32 v[82:83], v[82:83], s[62:63]
    v_pk_mul_f32 v[84:85], v[84:85], s[62:63]
    v_pk_mul_f32 v[86:87], v[86:87], s[62:63]
    v_pk_mul_f32 v[88:89], v[88:89], s[62:63]
    v_pk_mul_f32 v[90:91], v[90:91], s[62:63]
    v_pk_mul_f32 v[92:93], v[92:93], s[62:63]
    v_pk_mul_f32 v[94:95], v[94:95], s[62:63]
    v_pk_mul_f32 v[96:97], v[96:97], s[62:63]
    v_pk_mul_f32 v[98:99], v[98:99], s[62:63]
    v_pk_mul_f32 v[100:101], v[100:101], s[62:63]
    v_pk_mul_f32 v[102:103], v[102:103], s[62:63]
    v_pk_mul_f32 v[104:105], v[104:105], s[62:63]
    v_pk_mul_f32 v[106:107], v[106:107], s[62:63]
    v_pk_mul_f32 v[108:109], v[108:109], s[62:63]
    v_pk_mul_f32 v[110:111], v[110:111], s[62:63]
    v_pk_mul_f32 v[112:113], v[112:113], s[62:63]
    v_pk_mul_f32 v[114:115], v[114:115], s[62:63]
    v_pk_mul_f32 v[116:117], v[116:117], s[62:63]
    v_pk_mul_f32 v[118:119], v[118:119], s[62:63]
    v_pk_mul_f32 v[120:121], v[120:121], s[62:63]
    v_pk_mul_f32 v[122:123], v[122:123], s[62:63]
    v_pk_mul_f32 v[124:125], v[124:125], s[62:63]
    v_pk_mul_f32 v[126:127], v[126:127], s[62:63]
    v_pk_mul_f32 v[128:129], v[128:129], s[62:63]
    v_pk_mul_f32 v[130:131], v[130:131], s[62:63]
    v_pk_mul_f32 v[132:133], v[132:133], s[62:63]
    v_pk_mul_f32 v[134:135], v[134:135], s[62:63]
    v_pk_mul_f32 v[136:137], v[136:137], s[62:63]
    v_pk_mul_f32 v[138:139], v[138:139], s[62:63]
    v_pk_mul_f32 v[140:141], v[140:141], s[62:63]
    v_pk_mul_f32 v[142:143], v[142:143], s[62:63]
    v_max3_f32 v8, |v80|, |v81|, |v82|
    v_max3_f32 v8, v8, |v83|, |v84|
    v_max3_f32 v8, v8, |v85|, |v86|
    v_max3_f32 v8, v8, |v87|, |v88|
    v_max3_f32 v8, v8, |v89|, |v90|
    v_max3_f32 v8, v8, |v91|, |v92|
    v_max3_f32 v8, v8, |v93|, |v94|
    v_max3_f32 v8, v8, |v95|, |v96|
    v_max3_f32 v8, v8, |v97|, |v98|
    v_max3_f32 v8, v8, |v99|, |v100|
    v_max3_f32 v8, v8, |v101|, |v102|
    v_max3_f32 v8, v8, |v103|, |v104|
    v_max3_f32 v8, v8, |v105|, |v106|
    v_max3_f32 v8, v8, |v107|, |v108|
    v_max3_f32 v8, v8, |v109|, |v110|
    v_max3_f32 v8, v8, |v111|, |v112|
    v_max3_f32 v8, v8, |v113|, |v114|
    v_max3_f32 v8, v8, |v115|, |v116|
    v_max3_f32 v8, v8, |v117|, |v118|
    v_max3_f32 v8, v8, |v119|, |v120|
    v_max3_f32 v8, v8, |v121|, |v122|
    v_max3_f32 v8, v8, |v123|, |v124|
    v_max3_f32 v8, v8, |v125|, |v126|
    v_max3_f32 v8, v8, |v127|, |v128|
    v_max3_f32 v8, v8, |v129|, |v130|
    v_max3_f32 v8, v8, |v131|, |v132|
    v_max3_f32 v8, v8, |v133|, |v134|
    v_max3_f32 v8, v8, |v135|, |v136|
    v_max3_f32 v8, v8, |v137|, |v138|
    v_max3_f32 v8, v8, |v139|, |v140|
    v_max3_f32 v8, v8, |v141|, |v142|
    v_max_f32 v8, v8, |v143|
    v_cmp_nle_f32 vcc, v8, v9
    s_nop 3
    s_cmp_lg_u64 vcc, 0
    s_cbranch_scc1 K1_eq_slow
    v_exp_f32 v172, -v80
    v_exp_f32 v173, -v81
    v_exp_f32 v174, -v82
    v_exp_f32 v175, -v83
    v_exp_f32 v176, -v84
    v_exp_f32 v177, -v85
    v_exp_f32 v178, -v86
    v_exp_f32 v179, -v87
    v_exp_f32 v80, v80
    v_exp_f32 v81, v81
    v_exp_f32 v82, v82
    v_exp_f32 v83, v83
    v_exp_f32 v84, v84
    v_exp_f32 v85, v85
    v_exp_f32 v86, v86
    v_exp_f32 v87, v87
    v_cvt_pk_bf16_f32 v20, v172, v173
    v_cvt_pk_bf16_f32 v21, v174, v175
    v_cvt_pk_bf16_f32 v22, v176, v177
    v_cvt_pk_bf16_f32 v23, v178, v179
    v_cvt_pk_bf16_f32 v16, v80, v81
    v_cvt_pk_bf16_f32 v17, v82, v83
    v_cvt_pk_bf16_f32 v18, v84, v85
    v_cvt_pk_bf16_f32 v19, v86, v87
    buffer_store_dwordx4 v[20:23], v1, s[24:27], s3 offen offset:2048 sc1
    buffer_store_dwordx4 v[16:19], v1, s[24:27], s3 offen offset:0 sc1
    v_exp_f32 v180, -v88
    v_exp_f32 v181, -v89
    v_exp_f32 v182, -v90
    v_exp_f32 v183, -v91
    v_exp_f32 v184, -v92
    v_exp_f32 v185, -v93
    v_exp_f32 v186, -v94
    v_exp_f32 v187, -v95
    v_exp_f32 v88, v88
    v_exp_f32 v89, v89
    v_exp_f32 v90, v90
    v_exp_f32 v91, v91
    v_exp_f32 v92, v92
    v_exp_f32 v93, v93
    v_exp_f32 v94, v94
    v_exp_f32 v95, v95
    v_cvt_pk_bf16_f32 v28, v180, v181
    v_cvt_pk_bf16_f32 v29, v182, v183
    v_cvt_pk_bf16_f32 v30, v184, v185
    v_cvt_pk_bf16_f32 v31, v186, v187
    v_cvt_pk_bf16_f32 v24, v88, v89
    v_cvt_pk_bf16_f32 v25, v90, v91
    v_cvt_pk_bf16_f32 v26, v92, v93
    v_cvt_pk_bf16_f32 v27, v94, v95
    buffer_store_dwordx4 v[28:31], v1, s[24:27], s3 offen offset:3072 sc1
    buffer_store_dwordx4 v[24:27], v1, s[24:27], s3 offen offset:1024 sc1
    v_exp_f32 v172, -v96
    v_exp_f32 v173, -v97
    v_exp_f32 v174, -v98
    v_exp_f32 v175, -v99
    v_exp_f32 v176, -v100
    v_exp_f32 v177, -v101
    v_exp_f32 v178, -v102
    v_exp_f32 v179, -v103
    v_exp_f32 v96, v96
    v_exp_f32 v97, v97
    v_exp_f32 v98, v98
    v_exp_f32 v99, v99
    v_exp_f32 v100, v100
    v_exp_f32 v101, v101
    v_exp_f32 v102, v102
    v_exp_f32 v103, v103
    v_cvt_pk_bf16_f32 v52, v172, v173
    v_cvt_pk_bf16_f32 v53, v174, v175
    v_cvt_pk_bf16_f32 v54, v176, v177
    v_cvt_pk_bf16_f32 v55, v178, v179
    v_cvt_pk_bf16_f32 v48, v96, v97
    v_cvt_pk_bf16_f32 v49, v98, v99
    v_cvt_pk_bf16_f32 v50, v100, v101
    v_cvt_pk_bf16_f32 v51, v102, v103
    buffer_store_dwordx4 v[52:55], v2, s[24:27], s3 offen offset:2048 sc1
    buffer_store_dwordx4 v[48:51], v2, s[24:27], s3 offen offset:0 sc1
    v_exp_f32 v180, -v104
    v_exp_f32 v181, -v105
    v_exp_f32 v182, -v106
    v_exp_f32 v183, -v107
    v_exp_f32 v184, -v108
    v_exp_f32 v185, -v109
    v_exp_f32 v186, -v110
    v_exp_f32 v187, -v111
    v_exp_f32 v104, v104
    v_exp_f32 v105, v105
    v_exp_f32 v106, v106
    v_exp_f32 v107, v107
    v_exp_f32 v108, v108
    v_exp_f32 v109, v109
    v_exp_f32 v110, v110
    v_exp_f32 v111, v111
    v_cvt_pk_bf16_f32 v60, v180, v181
    v_cvt_pk_bf16_f32 v61, v182, v183
    v_cvt_pk_bf16_f32 v62, v184, v185
    v_cvt_pk_bf16_f32 v63, v186, v187
    v_cvt_pk_bf16_f32 v56, v104, v105
    v_cvt_pk_bf16_f32 v57, v106, v107
    v_cvt_pk_bf16_f32 v58, v108, v109
    v_cvt_pk_bf16_f32 v59, v110, v111
    buffer_store_dwordx4 v[60:63], v2, s[24:27], s3 offen offset:3072 sc1
    buffer_store_dwordx4 v[56:59], v2, s[24:27], s3 offen offset:1024 sc1
    v_exp_f32 v172, -v112
    v_exp_f32 v173, -v113
    v_exp_f32 v174, -v114
    v_exp_f32 v175, -v115
    v_exp_f32 v176, -v116
    v_exp_f32 v177, -v117
    v_exp_f32 v178, -v118
    v_exp_f32 v179, -v119
    v_exp_f32 v112, v112
    v_exp_f32 v113, v113
    v_exp_f32 v114, v114
    v_exp_f32 v115, v115
    v_exp_f32 v116, v116
    v_exp_f32 v117, v117
    v_exp_f32 v118, v118
    v_exp_f32 v119, v119
    v_cvt_pk_bf16_f32 v36, v172, v173
    v_cvt_pk_bf16_f32 v37, v174, v175
    v_cvt_pk_bf16_f32 v38, v176, v177
    v_cvt_pk_bf16_f32 v39, v178, v179
    v_cvt_pk_bf16_f32 v32, v112, v113
    v_cvt_pk_bf16_f32 v33, v114, v115
    v_cvt_pk_bf16_f32 v34, v116, v117
    v_cvt_pk_bf16_f32 v35, v118, v119
    buffer_store_dwordx4 v[36:39], v1, s[24:27], s37 offen offset:2048 sc1
    buffer_store_dwordx4 v[32:35], v1, s[24:27], s37 offen offset:0 sc1
    v_exp_f32 v180, -v120
    v_exp_f32 v181, -v121
    v_exp_f32 v182, -v122
    v_exp_f32 v183, -v123
    v_exp_f32 v184, -v124
    v_exp_f32 v185, -v125
    v_exp_f32 v186, -v126
    v_exp_f32 v187, -v127
    v_exp_f32 v120, v120
    v_exp_f32 v121, v121
    v_exp_f32 v122, v122
    v_exp_f32 v123, v123
    v_exp_f32 v124, v124
    v_exp_f32 v125, v125
    v_exp_f32 v126, v126
    v_exp_f32 v127, v127
    v_cvt_pk_bf16_f32 v44, v180, v181
    v_cvt_pk_bf16_f32 v45, v182, v183
    v_cvt_pk_bf16_f32 v46, v184, v185
    v_cvt_pk_bf16_f32 v47, v186, v187
    v_cvt_pk_bf16_f32 v40, v120, v121
    v_cvt_pk_bf16_f32 v41, v122, v123
    v_cvt_pk_bf16_f32 v42, v124, v125
    v_cvt_pk_bf16_f32 v43, v126, v127
    buffer_store_dwordx4 v[44:47], v1, s[24:27], s37 offen offset:3072 sc1
    buffer_store_dwordx4 v[40:43], v1, s[24:27], s37 offen offset:1024 sc1
    v_exp_f32 v172, -v128
    v_exp_f32 v173, -v129
    v_exp_f32 v174, -v130
    v_exp_f32 v175, -v131
    v_exp_f32 v176, -v132
    v_exp_f32 v177, -v133
    v_exp_f32 v178, -v134
    v_exp_f32 v179, -v135
    v_exp_f32 v128, v128
    v_exp_f32 v129, v129
    v_exp_f32 v130, v130
    v_exp_f32 v131, v131
    v_exp_f32 v132, v132
    v_exp_f32 v133, v133
    v_exp_f32 v134, v134
    v_exp_f32 v135, v135
    v_cvt_pk_bf16_f32 v68, v172, v173
    v_cvt_pk_bf16_f32 v69, v174, v175
    v_cvt_pk_bf16_f32 v70, v176, v177
    v_cvt_pk_bf16_f32 v71, v178, v179
    v_cvt_pk_bf16_f32 v64, v128, v129
    v_cvt_pk_bf16_f32 v65, v130, v131
    v_cvt_pk_bf16_f32 v66, v132, v133
    v_cvt_pk_bf16_f32 v67, v134, v135
    buffer_store_dwordx4 v[68:71], v2, s[24:27], s37 offen offset:2048 sc1
    buffer_store_dwordx4 v[64:67], v2, s[24:27], s37 offen offset:0 sc1
    v_exp_f32 v180, -v136
    v_exp_f32 v181, -v137
    v_exp_f32 v182, -v138
    v_exp_f32 v183, -v139
    v_exp_f32 v184, -v140
    v_exp_f32 v185, -v141
    v_exp_f32 v186, -v142
    v_exp_f32 v187, -v143
    v_exp_f32 v136, v136
    v_exp_f32 v137, v137
    v_exp_f32 v138, v138
    v_exp_f32 v139, v139
    v_exp_f32 v140, v140
    v_exp_f32 v141, v141
    v_exp_f32 v142, v142
    v_exp_f32 v143, v143
    v_cvt_pk_bf16_f32 v76, v180, v181
    v_cvt_pk_bf16_f32 v77, v182, v183
    v_cvt_pk_bf16_f32 v78, v184, v185
    v_cvt_pk_bf16_f32 v79, v186, v187
    v_cvt_pk_bf16_f32 v72, v136, v137
    v_cvt_pk_bf16_f32 v73, v138, v139
    v_cvt_pk_bf16_f32 v74, v140, v141
    v_cvt_pk_bf16_f32 v75, v142, v143
    buffer_store_dwordx4 v[76:79], v2, s[24:27], s37 offen offset:3072 sc1
    buffer_store_dwordx4 v[72:75], v2, s[24:27], s37 offen offset:1024 sc1
    s_endpgm
K1_eq_slow:
    v_max3_f32 v10, v80, v81, v82
    v_min3_f32 v12, v80, v81, v82
    v_max3_f32 v10, v10, v83, v84
    v_min3_f32 v12, v12, v83, v84
    v_max3_f32 v10, v10, v85, v86
    v_min3_f32 v12, v12, v85, v86
    v_max3_f32 v10, v10, v87, v88
    v_min3_f32 v12, v12, v87, v88
    v_max3_f32 v10, v10, v89, v90
    v_min3_f32 v12, v12, v89, v90
    v_max3_f32 v10, v10, v91, v92
    v_min3_f32 v12, v12, v91, v92
    v_max3_f32 v10, v10, v93, v94
    v_min3_f32 v12, v12, v93, v94
    v_max_f32 v10, v10, v95
    v_min_f32 v12, v12, v95
    v_mov_b32 v14, v10
    v_mov_b32 v15, v12
    s_nop 0
    v_permlane32_swap_b32 v10, v14
    v_permlane32_swap_b32 v12, v15
    v_max_f32 v10, v10, v14
    v_min_f32 v12, v12, v15
    v_sub_f32 v172, v80, v12
    v_sub_f32 v80, v80, v10
    v_sub_f32 v173, v81, v12
    v_sub_f32 v81, v81, v10
    v_sub_f32 v174, v82, v12
    v_sub_f32 v82, v82, v10
    v_sub_f32 v175, v83, v12
    v_sub_f32 v83, v83, v10
    v_sub_f32 v176, v84, v12
    v_sub_f32 v84, v84, v10
    v_sub_f32 v177, v85, v12
    v_sub_f32 v85, v85, v10
    v_sub_f32 v178, v86, v12
    v_sub_f32 v86, v86, v10
    v_sub_f32 v179, v87, v12
    v_sub_f32 v87, v87, v10
    v_sub_f32 v180, v88, v12
    v_sub_f32 v88, v88, v10
    v_sub_f32 v181, v89, v12
    v_sub_f32 v89, v89, v10
    v_sub_f32 v182, v90, v12
    v_sub_f32 v90, v90, v10
    v_sub_f32 v183, v91, v12
    v_sub_f32 v91, v91, v10
    v_sub_f32 v184, v92, v12
    v_sub_f32 v92, v92, v10
    v_sub_f32 v185, v93, v12
    v_sub_f32 v93, v93, v10
    v_sub_f32 v186, v94, v12
    v_sub_f32 v94, v94, v10
    v_sub_f32 v187, v95, v12
    v_sub_f32 v95, v95, v10
    v_exp_f32 v172, -v172
    v_exp_f32 v173, -v173
    v_exp_f32 v174, -v174
    v_exp_f32 v175, -v175
    v_exp_f32 v176, -v176
    v_exp_f32 v177, -v177
    v_exp_f32 v178, -v178
    v_exp_f32 v179, -v179
    v_exp_f32 v80, v80
    v_exp_f32 v81, v81
    v_exp_f32 v82, v82
    v_exp_f32 v83, v83
    v_exp_f32 v84, v84
    v_exp_f32 v85, v85
    v_exp_f32 v86, v86
    v_exp_f32 v87, v87
    v_cvt_pk_bf16_f32 v20, v172, v173
    v_cvt_pk_bf16_f32 v21, v174, v175
    v_cvt_pk_bf16_f32 v22, v176, v177
    v_cvt_pk_bf16_f32 v23, v178, v179
    v_cvt_pk_bf16_f32 v16, v80, v81
    v_cvt_pk_bf16_f32 v17, v82, v83
    v_cvt_pk_bf16_f32 v18, v84, v85
    v_cvt_pk_bf16_f32 v19, v86, v87
    buffer_store_dwordx4 v[20:23], v1, s[24:27], s3 offen offset:2048 sc1
    buffer_store_dwordx4 v[16:19], v1, s[24:27], s3 offen offset:0 sc1
    v_exp_f32 v180, -v180
    v_exp_f32 v181, -v181
    v_exp_f32 v182, -v182
    v_exp_f32 v183, -v183
    v_exp_f32 v184, -v184
    v_exp_f32 v185, -v185
    v_exp_f32 v186, -v186
    v_exp_f32 v187, -v187
    v_exp_f32 v88, v88
    v_exp_f32 v89, v89
    v_exp_f32 v90, v90
    v_exp_f32 v91, v91
    v_exp_f32 v92, v92
    v_exp_f32 v93, v93
    v_exp_f32 v94, v94
    v_exp_f32 v95, v95
    v_cvt_pk_bf16_f32 v28, v180, v181
    v_cvt_pk_bf16_f32 v29, v182, v183
    v_cvt_pk_bf16_f32 v30, v184, v185
    v_cvt_pk_bf16_f32 v31, v186, v187
    v_cvt_pk_bf16_f32 v24, v88, v89
    v_cvt_pk_bf16_f32 v25, v90, v91
    v_cvt_pk_bf16_f32 v26, v92, v93
    v_cvt_pk_bf16_f32 v27, v94, v95
    buffer_store_dwordx4 v[28:31], v1, s[24:27], s3 offen offset:3072 sc1
    buffer_store_dwordx4 v[24:27], v1, s[24:27], s3 offen offset:1024 sc1
    v_max3_f32 v10, v96, v97, v98
    v_min3_f32 v12, v96, v97, v98
    v_max3_f32 v10, v10, v99, v100
    v_min3_f32 v12, v12, v99, v100
    v_max3_f32 v10, v10, v101, v102
    v_min3_f32 v12, v12, v101, v102
    v_max3_f32 v10, v10, v103, v104
    v_min3_f32 v12, v12, v103, v104
    v_max3_f32 v10, v10, v105, v106
    v_min3_f32 v12, v12, v105, v106
    v_max3_f32 v10, v10, v107, v108
    v_min3_f32 v12, v12, v107, v108
    v_max3_f32 v10, v10, v109, v110
    v_min3_f32 v12, v12, v109, v110
    v_max_f32 v10, v10, v111
    v_min_f32 v12, v12, v111
    v_mov_b32 v14, v10
    v_mov_b32 v15, v12
    s_nop 0
    v_permlane32_swap_b32 v10, v14
    v_permlane32_swap_b32 v12, v15
    v_max_f32 v10, v10, v14
    v_min_f32 v12, v12, v15
    v_sub_f32 v172, v96, v12
    v_sub_f32 v96, v96, v10
    v_sub_f32 v173, v97, v12
    v_sub_f32 v97, v97, v10
    v_sub_f32 v174, v98, v12
    v_sub_f32 v98, v98, v10
    v_sub_f32 v175, v99, v12
    v_sub_f32 v99, v99, v10
    v_sub_f32 v176, v100, v12
    v_sub_f32 v100, v100, v10
    v_sub_f32 v177, v101, v12
    v_sub_f32 v101, v101, v10
    v_sub_f32 v178, v102, v12
    v_sub_f32 v102, v102, v10
    v_sub_f32 v179, v103, v12
    v_sub_f32 v103, v103, v10
    v_sub_f32 v180, v104, v12
    v_sub_f32 v104, v104, v10
    v_sub_f32 v181, v105, v12
    v_sub_f32 v105, v105, v10
    v_sub_f32 v182, v106, v12
    v_sub_f32 v106, v106, v10
    v_sub_f32 v183, v107, v12
    v_sub_f32 v107, v107, v10
    v_sub_f32 v184, v108, v12
    v_sub_f32 v108, v108, v10
    v_sub_f32 v185, v109, v12
    v_sub_f32 v109, v109, v10
    v_sub_f32 v186, v110, v12
    v_sub_f32 v110, v110, v10
    v_sub_f32 v187, v111, v12
    v_sub_f32 v111, v111, v10
    v_exp_f32 v172, -v172
    v_exp_f32 v173, -v173
    v_exp_f32 v174, -v174
    v_exp_f32 v175, -v175
    v_exp_f32 v176, -v176
    v_exp_f32 v177, -v177
    v_exp_f32 v178, -v178
    v_exp_f32 v179, -v179
    v_exp_f32 v96, v96
    v_exp_f32 v97, v97
    v_exp_f32 v98, v98
    v_exp_f32 v99, v99
    v_exp_f32 v100, v100
    v_exp_f32 v101, v101
    v_exp_f32 v102, v102
    v_exp_f32 v103, v103
    v_cvt_pk_bf16_f32 v52, v172, v173
    v_cvt_pk_bf16_f32 v53, v174, v175
    v_cvt_pk_bf16_f32 v54, v176, v177
    v_cvt_pk_bf16_f32 v55, v178, v179
    v_cvt_pk_bf16_f32 v48, v96, v97
    v_cvt_pk_bf16_f32 v49, v98, v99
    v_cvt_pk_bf16_f32 v50, v100, v101
    v_cvt_pk_bf16_f32 v51, v102, v103
    buffer_store_dwordx4 v[52:55], v2, s[24:27], s3 offen offset:2048 sc1
    buffer_store_dwordx4 v[48:51], v2, s[24:27], s3 offen offset:0 sc1
    v_exp_f32 v180, -v180
    v_exp_f32 v181, -v181
    v_exp_f32 v182, -v182
    v_exp_f32 v183, -v183
    v_exp_f32 v184, -v184
    v_exp_f32 v185, -v185
    v_exp_f32 v186, -v186
    v_exp_f32 v187, -v187
    v_exp_f32 v104, v104
    v_exp_f32 v105, v105
    v_exp_f32 v106, v106
    v_exp_f32 v107, v107
    v_exp_f32 v108, v108
    v_exp_f32 v109, v109
    v_exp_f32 v110, v110
    v_exp_f32 v111, v111
    v_cvt_pk_bf16_f32 v60, v180, v181
    v_cvt_pk_bf16_f32 v61, v182, v183
    v_cvt_pk_bf16_f32 v62, v184, v185
    v_cvt_pk_bf16_f32 v63, v186, v187
    v_cvt_pk_bf16_f32 v56, v104, v105
    v_cvt_pk_bf16_f32 v57, v106, v107
    v_cvt_pk_bf16_f32 v58, v108, v109
    v_cvt_pk_bf16_f32 v59, v110, v111
    buffer_store_dwordx4 v[60:63], v2, s[24:27], s3 offen offset:3072 sc1
    buffer_store_dwordx4 v[56:59], v2, s[24:27], s3 offen offset:1024 sc1
    v_max3_f32 v10, v112, v113, v114
    v_min3_f32 v12, v112, v113, v114
    v_max3_f32 v10, v10, v115, v116
    v_min3_f32 v12, v12, v115, v116
    v_max3_f32 v10, v10, v117, v118
    v_min3_f32 v12, v12, v117, v118
    v_max3_f32 v10, v10, v119, v120
    v_min3_f32 v12, v12, v119, v120
    v_max3_f32 v10, v10, v121, v122
    v_min3_f32 v12, v12, v121, v122
    v_max3_f32 v10, v10, v123, v124
    v_min3_f32 v12, v12, v123, v124
    v_max3_f32 v10, v10, v125, v126
    v_min3_f32 v12, v12, v125, v126
    v_max_f32 v10, v10, v127
    v_min_f32 v12, v12, v127
    v_mov_b32 v14, v10
    v_mov_b32 v15, v12
    s_nop 0
    v_permlane32_swap_b32 v10, v14
    v_permlane32_swap_b32 v12, v15
    v_max_f32 v10, v10, v14
    v_min_f32 v12, v12, v15
    v_sub_f32 v172, v112, v12
    v_sub_f32 v112, v112, v10
    v_sub_f32 v173, v113, v12
    v_sub_f32 v113, v113, v10
    v_sub_f32 v174, v114, v12
    v_sub_f32 v114, v114, v10
    v_sub_f32 v175, v115, v12
    v_sub_f32 v115, v115, v10
    v_sub_f32 v176, v116, v12
    v_sub_f32 v116, v116, v10
    v_sub_f32 v177, v117, v12
    v_sub_f32 v117, v117, v10
    v_sub_f32 v178, v118, v12
    v_sub_f32 v118, v118, v10
    v_sub_f32 v179, v119, v12
    v_sub_f32 v119, v119, v10
    v_sub_f32 v180, v120, v12
    v_sub_f32 v120, v120, v10
    v_sub_f32 v181, v121, v12
    v_sub_f32 v121, v121, v10
    v_sub_f32 v182, v122, v12
    v_sub_f32 v122, v122, v10
    v_sub_f32 v183, v123, v12
    v_sub_f32 v123, v123, v10
    v_sub_f32 v184, v124, v12
    v_sub_f32 v124, v124, v10
    v_sub_f32 v185, v125, v12
    v_sub_f32 v125, v125, v10
    v_sub_f32 v186, v126, v12
    v_sub_f32 v126, v126, v10
    v_sub_f32 v187, v127, v12
    v_sub_f32 v127, v127, v10
    v_exp_f32 v172, -v172
    v_exp_f32 v173, -v173
    v_exp_f32 v174, -v174
    v_exp_f32 v175, -v175
    v_exp_f32 v176, -v176
    v_exp_f32 v177, -v177
    v_exp_f32 v178, -v178
    v_exp_f32 v179, -v179
    v_exp_f32 v112, v112
    v_exp_f32 v113, v113
    v_exp_f32 v114, v114
    v_exp_f32 v115, v115
    v_exp_f32 v116, v116
    v_exp_f32 v117, v117
    v_exp_f32 v118, v118
    v_exp_f32 v119, v119
    v_cvt_pk_bf16_f32 v36, v172, v173
    v_cvt_pk_bf16_f32 v37, v174, v175
    v_cvt_pk_bf16_f32 v38, v176, v177
    v_cvt_pk_bf16_f32 v39, v178, v179
    v_cvt_pk_bf16_f32 v32, v112, v113
    v_cvt_pk_bf16_f32 v33, v114, v115
    v_cvt_pk_bf16_f32 v34, v116, v117
    v_cvt_pk_bf16_f32 v35, v118, v119
    buffer_store_dwordx4 v[36:39], v1, s[24:27], s37 offen offset:2048 sc1
    buffer_store_dwordx4 v[32:35], v1, s[24:27], s37 offen offset:0 sc1
    v_exp_f32 v180, -v180
    v_exp_f32 v181, -v181
    v_exp_f32 v182, -v182
    v_exp_f32 v183, -v183
    v_exp_f32 v184, -v184
    v_exp_f32 v185, -v185
    v_exp_f32 v186, -v186
    v_exp_f32 v187, -v187
    v_exp_f32 v120, v120
    v_exp_f32 v121, v121
    v_exp_f32 v122, v122
    v_exp_f32 v123, v123
    v_exp_f32 v124, v124
    v_exp_f32 v125, v125
    v_exp_f32 v126, v126
    v_exp_f32 v127, v127
    v_cvt_pk_bf16_f32 v44, v180, v181
    v_cvt_pk_bf16_f32 v45, v182, v183
    v_cvt_pk_bf16_f32 v46, v184, v185
    v_cvt_pk_bf16_f32 v47, v186, v187
    v_cvt_pk_bf16_f32 v40, v120, v121
    v_cvt_pk_bf16_f32 v41, v122, v123
    v_cvt_pk_bf16_f32 v42, v124, v125
    v_cvt_pk_bf16_f32 v43, v126, v127
    buffer_store_dwordx4 v[44:47], v1, s[24:27], s37 offen offset:3072 sc1
    buffer_store_dwordx4 v[40:43], v1, s[24:27], s37 offen offset:1024 sc1
    v_max3_f32 v10, v128, v129, v130
    v_min3_f32 v12, v128, v129, v130
    v_max3_f32 v10, v10, v131, v132
    v_min3_f32 v12, v12, v131, v132
    v_max3_f32 v10, v10, v133, v134
    v_min3_f32 v12, v12, v133, v134
    v_max3_f32 v10, v10, v135, v136
    v_min3_f32 v12, v12, v135, v136
    v_max3_f32 v10, v10, v137, v138
    v_min3_f32 v12, v12, v137, v138
    v_max3_f32 v10, v10, v139, v140
    v_min3_f32 v12, v12, v139, v140
    v_max3_f32 v10, v10, v141, v142
    v_min3_f32 v12, v12, v141, v142
    v_max_f32 v10, v10, v143
    v_min_f32 v12, v12, v143
    v_mov_b32 v14, v10
    v_mov_b32 v15, v12
    s_nop 0
    v_permlane32_swap_b32 v10, v14
    v_permlane32_swap_b32 v12, v15
    v_max_f32 v10, v10, v14
    v_min_f32 v12, v12, v15
    v_sub_f32 v172, v128, v12
    v_sub_f32 v128, v128, v10
    v_sub_f32 v173, v129, v12
    v_sub_f32 v129, v129, v10
    v_sub_f32 v174, v130, v12
    v_sub_f32 v130, v130, v10
    v_sub_f32 v175, v131, v12
    v_sub_f32 v131, v131, v10
    v_sub_f32 v176, v132, v12
    v_sub_f32 v132, v132, v10
    v_sub_f32 v177, v133, v12
    v_sub_f32 v133, v133, v10
    v_sub_f32 v178, v134, v12
    v_sub_f32 v134, v134, v10
    v_sub_f32 v179, v135, v12
    v_sub_f32 v135, v135, v10
    v_sub_f32 v180, v136, v12
    v_sub_f32 v136, v136, v10
    v_sub_f32 v181, v137, v12
    v_sub_f32 v137, v137, v10
    v_sub_f32 v182, v138, v12
    v_sub_f32 v138, v138, v10
    v_sub_f32 v183, v139, v12
    v_sub_f32 v139, v139, v10
    v_sub_f32 v184, v140, v12
    v_sub_f32 v140, v140, v10
    v_sub_f32 v185, v141, v12
    v_sub_f32 v141, v141, v10
    v_sub_f32 v186, v142, v12
    v_sub_f32 v142, v142, v10
    v_sub_f32 v187, v143, v12
    v_sub_f32 v143, v143, v10
    v_exp_f32 v172, -v172
    v_exp_f32 v173, -v173
    v_exp_f32 v174, -v174
    v_exp_f32 v175, -v175
    v_exp_f32 v176, -v176
    v_exp_f32 v177, -v177
    v_exp_f32 v178, -v178
    v_exp_f32 v179, -v179
    v_exp_f32 v128, v128
    v_exp_f32 v129, v129
    v_exp_f32 v130, v130
    v_exp_f32 v131, v131
    v_exp_f32 v132, v132
    v_exp_f32 v133, v133
    v_exp_f32 v134, v134
    v_exp_f32 v135, v135
    v_cvt_pk_bf16_f32 v68, v172, v173
    v_cvt_pk_bf16_f32 v69, v174, v175
    v_cvt_pk_bf16_f32 v70, v176, v177
    v_cvt_pk_bf16_f32 v71, v178, v179
    v_cvt_pk_bf16_f32 v64, v128, v129
    v_cvt_pk_bf16_f32 v65, v130, v131
    v_cvt_pk_bf16_f32 v66, v132, v133
    v_cvt_pk_bf16_f32 v67, v134, v135
    buffer_store_dwordx4 v[68:71], v2, s[24:27], s37 offen offset:2048 sc1
    buffer_store_dwordx4 v[64:67], v2, s[24:27], s37 offen offset:0 sc1
    v_exp_f32 v180, -v180
    v_exp_f32 v181, -v181
    v_exp_f32 v182, -v182
    v_exp_f32 v183, -v183
    v_exp_f32 v184, -v184
    v_exp_f32 v185, -v185
    v_exp_f32 v186, -v186
    v_exp_f32 v187, -v187
    v_exp_f32 v136, v136
    v_exp_f32 v137, v137
    v_exp_f32 v138, v138
    v_exp_f32 v139, v139
    v_exp_f32 v140, v140
    v_exp_f32 v141, v141
    v_exp_f32 v142, v142
    v_exp_f32 v143, v143
    v_cvt_pk_bf16_f32 v76, v180, v181
    v_cvt_pk_bf16_f32 v77, v182, v183
    v_cvt_pk_bf16_f32 v78, v184, v185
    v_cvt_pk_bf16_f32 v79, v186, v187
    v_cvt_pk_bf16_f32 v72, v136, v137
    v_cvt_pk_bf16_f32 v73, v138, v139
    v_cvt_pk_bf16_f32 v74, v140, v141
    v_cvt_pk_bf16_f32 v75, v142, v143
    buffer_store_dwordx4 v[76:79], v2, s[24:27], s37 offen offset:3072 sc1
    buffer_store_dwordx4 v[72:75], v2, s[24:27], s37 offen offset:1024 sc1
    s_endpgm
K1_T1:
    s_sub_u32 s3, s40, 4
    s_lshl_b32 s3, s3, 8
    s_add_u32 s42, s3, 2048
    s_add_u32 s37, s3, 4096
    v_mul_u32_u24 v1, 6144, v1
    v_add_u32 v3, v3, v1
    s_waitcnt lgkmcnt(0)
    s_mov_b32 s8, s44
    s_and_b32 s9, s45, 0xffff
    s_mov_b32 s10, 4194304
    s_mov_b32 s11, 0x00020000
    s_add_u32 s12, s46, s42
    s_addc_u32 s13, s47, 0
    s_sub_u32 s12, s12, 1024
    s_subb_u32 s13, s13, 0
    s_and_b32 s13, s13, 0xffff
    s_sub_u32 s14, 6292480, s42
    s_mov_b32 s15, 0x00020000
    s_add_u32 s16, s46, s37
    s_addc_u32 s17, s47, 0
    s_sub_u32 s16, s16, 2048
    s_subb_u32 s17, s17, 0
    s_and_b32 s17, s17, 0xffff
    s_sub_u32 s18, 6293504, s37
    s_mov_b32 s19, 0x00020000
    s_mov_b32 m0, s31
    s_add_u32 s31, s31, 26624
    buffer_load_dwordx4 v2, s[8:11], s28 offen lds
    buffer_load_dwordx4 v3, s[12:15], s29 offen offset:1024 lds
    buffer_load_dwordx4 v3, s[16:19], s29 offen offset:2048 lds
    s_add_u32 s28, s28, 64
    s_add_u32 s29, s29, 196608
    s_mov_b32 m0, s31
    s_add_u32 s31, s31, 26624
    buffer_load_dwordx4 v2, s[8:11], s28 offen lds
    buffer_load_dwordx4 v3, s[12:15], s29 offen offset:1024 lds
    buffer_load_dwordx4 v3, s[16:19], s29 offen offset:2048 lds
    s_add_u32 s28, s28, 64
    s_add_u32 s29, s29, 196608
    v_lshrrev_b32 v13, 5, v0
    s_mov_b32 s20, s48
    s_and_b32 s21, s49, 0xffff
    s_mov_b32 s22, 65536
    s_mov_b32 s23, 0x00020000
    s_and_b32 s39, s34, 3
    s_sub_u32 s3, s40, 4
    s_lshl_b32 s3, s3, 2
    s_add_u32 s36, s3, s39
    s_lshl_b32 s30, s36, 11
    v_lshlrev_b32 v4, 4, v0
    s_mov_b32 s62, 0x3fb8aa3b
    s_mov_b32 s63, 0x3fb8aa3b
    s_lshr_b32 s38, s34, 2
    s_and_b32 s39, s34, 3
    v_and_b32 v10, 15, v0
    v_lshlrev_b32 v5, 6, v10
    v_bfe_u32 v11, v0, 4, 1
    v_mul_u32_u24 v15, 3328, v11
    v_add_u32 v5, v5, v15
    s_mul_i32 s3, s38, 13312
    v_add_u32 v5, s3, v5
    v_xor_b32 v7, v13, v12
    v_xor_b32 v15, 2, v7
    v_lshl_add_u32 v6, v15, 4, v5
    v_lshl_add_u32 v5, v7, 4, v5
    v_mul_u32_u24 v7, 6656, v13
    v_lshl_add_u32 v7, v12, 6, v7
    v_lshl_add_u32 v7, v11, 5, v7
    v_lshl_add_u32 v7, v14, 3, v7
    s_lshl_b32 s3, s39, 8
    s_add_u32 s3, s3, 1024
    v_add_u32 v7, s3, v7
    s_mov_b32 s32, 0
    s_mov_b32 s43, 0
    s_mov_b32 s65, 0
    s_mov_b32 s64, 4294834176
    v_mov_b32 v16, 0
    v_mov_b32 v17, 0
    v_mov_b32 v18, 0
    v_mov_b32 v19, 0
    v_mov_b32 v20, 0
    v_mov_b32 v21, 0
    v_mov_b32 v22, 0
    v_mov_b32 v23, 0
    v_mov_b32 v24, 0
    v_mov_b32 v25, 0
    v_mov_b32 v26, 0
    v_mov_b32 v27, 0
    v_mov_b32 v28, 0
    v_mov_b32 v29, 0
    v_mov_b32 v30, 0
    v_mov_b32 v31, 0
    v_mov_b32 v32, 0
    v_mov_b32 v33, 0
    v_mov_b32 v34, 0
    v_mov_b32 v35, 0
    v_mov_b32 v36, 0
    v_mov_b32 v37, 0
    v_mov_b32 v38, 0
    v_mov_b32 v39, 0
    v_mov_b32 v40, 0
    v_mov_b32 v41, 0
    v_mov_b32 v42, 0
    v_mov_b32 v43, 0
    v_mov_b32 v44, 0
    v_mov_b32 v45, 0
    v_mov_b32 v46, 0
    v_mov_b32 v47, 0
    v_mov_b32 v48, 0
    v_mov_b32 v49, 0
    v_mov_b32 v50, 0
    v_mov_b32 v51, 0
    v_mov_b32 v52, 0
    v_mov_b32 v53, 0
    v_mov_b32 v54, 0
    v_mov_b32 v55, 0
    v_mov_b32 v56, 0
    v_mov_b32 v57, 0
    v_mov_b32 v58, 0
    v_mov_b32 v59, 0
    v_mov_b32 v60, 0
    v_mov_b32 v61, 0
    v_mov_b32 v62, 0
    v_mov_b32 v63, 0
    v_mov_b32 v64, 0
    v_mov_b32 v65, 0
    v_mov_b32 v66, 0
    v_mov_b32 v67, 0
    v_mov_b32 v68, 0
    v_mov_b32 v69, 0
    v_mov_b32 v70, 0
    v_mov_b32 v71, 0
    v_mov_b32 v72, 0
    v_mov_b32 v73, 0
    v_mov_b32 v74, 0
    v_mov_b32 v75, 0
    v_mov_b32 v76, 0
    v_mov_b32 v77, 0
    v_mov_b32 v78, 0
    v_mov_b32 v79, 0
    s_mov_b32 s24, s60
    s_and_b32 s25, s61, 0xffff
    s_mov_b32 s26, 27267072
    s_mov_b32 s27, 0x00020000
    s_mov_b32 m0, s31
    s_add_u32 s31, s31, 26624
    buffer_load_dwordx4 v2, s[8:11], s28 offen lds
    buffer_load_dwordx4 v3, s[12:15], s29 offen offset:1024 lds
    buffer_load_dwordx4 v3, s[16:19], s29 offen offset:2048 lds
    s_add_u32 s28, s28, 64
    s_add_u32 s29, s29, 196608
    s_mov_b32 m0, s31
    s_add_u32 s31, s31, 26624
    buffer_load_dwordx4 v2, s[8:11], s28 offen lds
    buffer_load_dwordx4 v3, s[12:15], s29 offen offset:1024 lds
    buffer_load_dwordx4 v3, s[16:19], s29 offen offset:2048 lds
    s_add_u32 s28, s28, 64
    s_add_u32 s29, s29, 196608
    s_mov_b32 m0, s31
    s_add_u32 s31, s31, 26624
    buffer_load_dwordx4 v2, s[8:11], s28 offen lds
    buffer_load_dwordx4 v3, s[12:15], s29 offen offset:1024 lds
    buffer_load_dwordx4 v3, s[16:19], s29 offen offset:2048 lds
    s_add_u32 s28, s28, 64
    s_add_u32 s29, s29, 196608
    s_lshr_b32 s67, s34, 1
    s_add_u32 s69, s67, 2
    s_lshl_b32 s67, s67, 2
    s_sub_i32 s67, s67, 0
    s_max_i32 s67, s67, 0
    v_lshrrev_b32 v188, 1, v0
    v_lshlrev_b32 v188, 11, v188
    v_and_b32 v189, 1, v0
    v_lshl_add_u32 v188, v189, 7, v188
    s_lshr_b32 s3, s2, 6
    s_and_b32 s3, s3, 3
    s_lshl_b32 s3, s3, 5
    s_lshl_b32 s66, s35, 7
    s_add_u32 s3, s3, s66
    s_lshl_b32 s66, s3, 11
    s_lshl_b32 s3, s69, 8
    s_add_u32 s66, s66, s3
    s_mov_b32 s68, 1024
    s_bitcmp0_b32 s34, 0
    s_cbranch_scc1 rpf_2
    v_lshrrev_b32 v188, 2, v0
    v_mul_u32_u24 v188, 6144, v188
    v_lshl_add_u32 v188, v189, 7, v188
    v_bfe_u32 v189, v0, 1, 1
    v_mul_u32_u24 v189, 2048, v189
    v_add_u32 v188, v188, v189
    s_and_b32 s3, s35, 7
    s_lshl_b32 s3, s3, 4
    s_lshl_b32 s66, s69, 7
    s_add_u32 s3, s3, s66
    s_mul_i32 s66, s3, 6144
    s_mov_b32 s68, 3145728
rpf_2:
    s_waitcnt vmcnt(12)
    s_barrier
    ds_read_b128 v[80:83], v5 offset:0
    ds_read_b64_tr_b16 v[88:89], v7 offset:0
    ds_read_b64_tr_b16 v[90:91], v7 offset:3328
    ds_read_b64_tr_b16 v[92:93], v7 offset:1024
    ds_read_b64_tr_b16 v[94:95], v7 offset:4352
    ds_read_b128 v[84:87], v5 offset:6656
.p2align 6
K1_T1_loop:
    s_waitcnt lgkmcnt(0)
    v_mfma_f32_32x32x16_bf16 v[16:31], v[88:91], v[80:83], v[16:31]
    ds_read_b128 v[96:99], v6 offset:0
    ds_read_b64_tr_b16 v[104:105], v7 offset:13312
    v_mfma_f32_32x32x16_bf16 v[32:47], v[80:83], v[92:95], v[32:47]
    ds_read_b64_tr_b16 v[106:107], v7 offset:16640
    ds_read_b64_tr_b16 v[108:109], v7 offset:14336
    v_mfma_f32_32x32x16_bf16 v[48:63], v[88:91], v[84:87], v[48:63]
    ds_read_b64_tr_b16 v[110:111], v7 offset:17664
    ds_read_b128 v[100:103], v6 offset:6656
    s_cmp_ge_u32 s32, 28
    v_mfma_f32_32x32x16_bf16 v[64:79], v[84:87], v[92:95], v[64:79]
    s_cbranch_scc1 K1_T1_loop_tw
    s_waitcnt vmcnt(9)
K1_T1_loop_back:
    s_barrier
    s_add_u32 s43, s43, 1
    s_cmp_eq_u32 s43, 6
    s_cselect_b32 s33, s64, 26624
    s_cselect_b32 s43, 0, s43
    s_waitcnt lgkmcnt(0)
    v_mfma_f32_32x32x16_bf16 v[16:31], v[104:107], v[96:99], v[16:31]
    v_add_u32 v5, s33, v5
    v_add_u32 v7, s33, v7
    ds_read_b128 v[80:83], v5 offset:0
    ds_read_b64_tr_b16 v[88:89], v7 offset:0
    v_mfma_f32_32x32x16_bf16 v[32:47], v[96:99], v[108:111], v[32:47]
    ds_read_b64_tr_b16 v[90:91], v7 offset:3328
    ds_read_b64_tr_b16 v[92:93], v7 offset:1024
    ds_read_b64_tr_b16 v[94:95], v7 offset:4352
    ds_read_b128 v[84:87], v5 offset:6656
    s_cmp_ge_u32 s32, 27
    v_mfma_f32_32x32x16_bf16 v[48:63], v[104:107], v[100:103], v[48:63]
    v_add_u32 v6, s33, v6
    s_cbranch_scc1 K1_T1_loop_pd
    s_mov_b32 m0, s31
    s_add_u32 s31, s31, 26624
    buffer_load_dwordx4 v2, s[8:11], s28 offen lds
    buffer_load_dwordx4 v3, s[12:15], s29 offen offset:1024 lds
    buffer_load_dwordx4 v3, s[16:19], s29 offen offset:2048 lds
    s_add_u32 s28, s28, 64
    s_add_u32 s29, s29, 196608
    s_cmp_ge_u32 s31, s41
    s_cselect_b32 s3, 159744, 0
    s_sub_u32 s31, s31, s3
    s_cmp_eq_u32 s32, s67
    s_cbranch_scc1 K1_T1_loop_rpf
K1_T1_loop_nodma:
    s_add_u32 s32, s32, 1
    s_cmp_lt_u32 s32, 32
    v_mfma_f32_32x32x16_bf16 v[64:79], v[100:103], v[108:111], v[64:79]
    s_cbranch_scc1 K1_T1_loop
    s_branch K1_T1_loop_done
K1_T1_loop_tw:
    s_cmp_eq_u32 s32, 28
    s_cbranch_scc1 K1_T1_loop_tw2
    s_cmp_eq_u32 s32, 29
    s_cbranch_scc1 K1_T1_loop_tw1
    s_waitcnt vmcnt(2)
    s_cmp_eq_u32 s32, 30
    s_cbranch_scc1 K1_T1_loop_back
    v_lshlrev_b32 v8, 8, v13
    v_lshl_add_u32 v8, v12, 6, v8
    v_lshl_add_u32 v8, v11, 5, v8
    v_lshl_add_u32 v8, v14, 3, v8
    v_add_u32 v8, s65, v8
    s_waitcnt vmcnt(0)
    ds_read_b64_tr_b16 v[156:157], v8 offset:0
    ds_read_b64_tr_b16 v[158:159], v8 offset:512
    ds_read_b64_tr_b16 v[160:161], v8 offset:1024
    ds_read_b64_tr_b16 v[162:163], v8 offset:1536
    s_waitcnt lgkmcnt(0)
    s_branch K1_T1_loop_back
K1_T1_loop_tw2:
    s_waitcnt vmcnt(8)
    s_branch K1_T1_loop_back
K1_T1_loop_tw1:
    s_waitcnt vmcnt(5)
    s_branch K1_T1_loop_back
K1_T1_loop_pd:
    s_cmp_ge_u32 s32, 28
    s_cbranch_scc1 K1_T1_loop_nodma
    s_mov_b32 m0, s31
    s_cmp_eq_u32 s32, 27
    s_cselect_b32 s65, s31, s65
    s_add_u32 s31, s31, 26624
    buffer_load_dwordx4 v4, s[20:23], s30 offen lds
    buffer_load_dwordx4 v4, s[20:23], s30 offen offset:1024 lds
    s_add_u32 s30, s30, 8192
    s_branch K1_T1_loop_nodma
K1_T1_loop_rpf:
    s_bitcmp0_b32 s34, 0
    s_cbranch_scc1 K1_T1_loop_rpfx
    buffer_load_dword v190, v188, s[12:15], s66 offen offset:1024
    s_branch K1_T1_loop_rpfc
K1_T1_loop_rpfx:
    buffer_load_dword v190, v188, s[8:11], s66 offen
K1_T1_loop_rpfc:
    s_add_u32 s66, s66, s68
    s_add_u32 s69, s69, 4
    s_lshr_b32 s67, s34, 1
    s_lshl_b32 s67, s67, 2
    s_add_u32 s67, s67, 16
    s_cmp_ge_u32 s69, 8
    s_cselect_b32 s67, 99, s67
    s_branch K1_T1_loop_nodma
K1_T1_loop_done:
    s_nop 15
    s_waitcnt lgkmcnt(0)
    v_mov_b32 v9, 0x42700000
    v_cvt_pk_bf16_f32 v16, v16, v17
    v_cvt_pk_bf16_f32 v17, v18, v19
    v_cvt_pk_bf16_f32 v18, v20, v21
    v_cvt_pk_bf16_f32 v19, v22, v23
    v_cvt_pk_bf16_f32 v20, v24, v25
    v_cvt_pk_bf16_f32 v21, v26, v27
    v_cvt_pk_bf16_f32 v22, v28, v29
    v_cvt_pk_bf16_f32 v23, v30, v31
    v_mfma_f32_32x32x16_bf16 v[124:139], v[156:159], v[16:19], 0
    s_nop 0
    v_mfma_f32_32x32x16_bf16 v[124:139], v[160:163], v[20:23], v[124:139]
    v_cvt_pk_bf16_f32 v48, v48, v49
    v_cvt_pk_bf16_f32 v49, v50, v51
    v_cvt_pk_bf16_f32 v50, v52, v53
    v_cvt_pk_bf16_f32 v51, v54, v55
    v_cvt_pk_bf16_f32 v52, v56, v57
    v_cvt_pk_bf16_f32 v53, v58, v59
    v_cvt_pk_bf16_f32 v54, v60, v61
    v_cvt_pk_bf16_f32 v55, v62, v63
    v_mfma_f32_32x32x16_bf16 v[140:155], v[156:159], v[48:51], 0
    s_nop 0
    v_mfma_f32_32x32x16_bf16 v[140:155], v[160:163], v[52:55], v[140:155]
    v_cvt_pk_bf16_f32 v32, v32, v33
    v_cvt_pk_bf16_f32 v33, v34, v35
    v_cvt_pk_bf16_f32 v34, v36, v37
    v_cvt_pk_bf16_f32 v35, v38, v39
    v_cvt_pk_bf16_f32 v36, v40, v41
    v_cvt_pk_bf16_f32 v37, v42, v43
    v_cvt_pk_bf16_f32 v38, v44, v45
    v_cvt_pk_bf16_f32 v39, v46, v47
    v_cvt_pk_bf16_f32 v64, v64, v65
    v_cvt_pk_bf16_f32 v65, v66, v67
    v_cvt_pk_bf16_f32 v66, v68, v69
    v_cvt_pk_bf16_f32 v67, v70, v71
    v_cvt_pk_bf16_f32 v68, v72, v73
    v_cvt_pk_bf16_f32 v69, v74, v75
    v_cvt_pk_bf16_f32 v70, v76, v77
    v_cvt_pk_bf16_f32 v71, v78, v79
    s_mul_i32 s3, s34, 8704
    s_add_u32 s3, s3, 53248
    v_and_b32 v1, 31, v0
    v_mul_u32_u24 v1, 136, v1
    v_lshl_add_u32 v1, v13, 3, v1
    v_add_u32 v1, s3, v1
    v_lshl_add_u32 v2, v13, 2, v12
    v_mul_u32_u24 v2, 136, v2
    v_bfe_u32 v3, v0, 4, 1
    v_lshl_add_u32 v2, v3, 5, v2
    v_lshl_add_u32 v2, v14, 3, v2
    v_add_u32 v2, s3, v2
    v_lshrrev_b32 v3, 2, v0
    v_xor_b32 v3, v3, v0
    v_and_b32 v3, 4, v3
    v_or_b32 v3, v3, v14
    v_cmp_eq_u32 vcc, 0, v3
    v_mov_b32 v4, 0x3f803f80
    v_mov_b32 v5, 0
    v_cndmask_b32 v120, v5, v4, vcc
    v_cndmask_b32 v121, v5, v4, vcc
    v_cndmask_b32 v122, v5, v4, vcc
    v_cndmask_b32 v123, v5, v4, vcc
    v_pk_mul_f32 v[124:125], v[124:125], s[62:63]
    v_pk_mul_f32 v[126:127], v[126:127], s[62:63]
    v_pk_mul_f32 v[128:129], v[128:129], s[62:63]
    v_pk_mul_f32 v[130:131], v[130:131], s[62:63]
    v_pk_mul_f32 v[132:133], v[132:133], s[62:63]
    v_pk_mul_f32 v[134:135], v[134:135], s[62:63]
    v_pk_mul_f32 v[136:137], v[136:137], s[62:63]
    v_pk_mul_f32 v[138:139], v[138:139], s[62:63]
    v_pk_mul_f32 v[140:141], v[140:141], s[62:63]
    v_pk_mul_f32 v[142:143], v[142:143], s[62:63]
    v_pk_mul_f32 v[144:145], v[144:145], s[62:63]
    v_pk_mul_f32 v[146:147], v[146:147], s[62:63]
    v_pk_mul_f32 v[148:149], v[148:149], s[62:63]
    v_pk_mul_f32 v[150:151], v[150:151], s[62:63]
    v_pk_mul_f32 v[152:153], v[152:153], s[62:63]
    v_pk_mul_f32 v[154:155], v[154:155], s[62:63]
    v_max3_f32 v8, |v124|, |v125|, |v126|
    v_max3_f32 v8, v8, |v127|, |v128|
    v_max3_f32 v8, v8, |v129|, |v130|
    v_max3_f32 v8, v8, |v131|, |v132|
    v_max3_f32 v8, v8, |v133|, |v134|
    v_max3_f32 v8, v8, |v135|, |v136|
    v_max3_f32 v8, v8, |v137|, |v138|
    v_max3_f32 v8, v8, |v139|, |v140|
    v_max3_f32 v8, v8, |v141|, |v142|
    v_max3_f32 v8, v8, |v143|, |v144|
    v_max3_f32 v8, v8, |v145|, |v146|
    v_max3_f32 v8, v8, |v147|, |v148|
    v_max3_f32 v8, v8, |v149|, |v150|
    v_max3_f32 v8, v8, |v151|, |v152|
    v_max3_f32 v8, v8, |v153|, |v154|
    v_max_f32 v8, v8, |v155|
    v_cmp_nle_f32 vcc, v8, v9
    s_nop 3
    s_cmp_lg_u64 vcc, 0
    s_cbranch_scc1 K1_kv_slow
    v_exp_f32 v80, -v124
    v_exp_f32 v124, v124
    v_exp_f32 v81, -v125
    v_exp_f32 v125, v125
    v_exp_f32 v82, -v126
    v_exp_f32 v126, v126
    v_exp_f32 v83, -v127
    v_exp_f32 v127, v127
    v_exp_f32 v84, -v128
    v_exp_f32 v128, v128
    v_exp_f32 v85, -v129
    v_exp_f32 v129, v129
    v_exp_f32 v86, -v130
    v_exp_f32 v130, v130
    v_exp_f32 v87, -v131
    v_exp_f32 v131, v131
    v_exp_f32 v88, -v132
    v_exp_f32 v132, v132
    v_exp_f32 v89, -v133
    v_exp_f32 v133, v133
    v_exp_f32 v90, -v134
    v_exp_f32 v134, v134
    v_exp_f32 v91, -v135
    v_exp_f32 v135, v135
    v_exp_f32 v92, -v136
    v_exp_f32 v136, v136
    v_exp_f32 v93, -v137
    v_exp_f32 v137, v137
    v_exp_f32 v94, -v138
    v_exp_f32 v138, v138
    v_exp_f32 v95, -v139
    v_exp_f32 v139, v139
    v_exp_f32 v96, -v140
    v_exp_f32 v140, v140
    v_exp_f32 v97, -v141
    v_exp_f32 v141, v141
    v_exp_f32 v98, -v142
    v_exp_f32 v142, v142
    v_exp_f32 v99, -v143
    v_exp_f32 v143, v143
    v_exp_f32 v100, -v144
    v_exp_f32 v144, v144
    v_exp_f32 v101, -v145
    v_exp_f32 v145, v145
    v_exp_f32 v102, -v146
    v_exp_f32 v146, v146
    v_exp_f32 v103, -v147
    v_exp_f32 v147, v147
    v_exp_f32 v104, -v148
    v_exp_f32 v148, v148
    v_exp_f32 v105, -v149
    v_exp_f32 v149, v149
    v_exp_f32 v106, -v150
    v_exp_f32 v150, v150
    v_exp_f32 v107, -v151
    v_exp_f32 v151, v151
    v_exp_f32 v108, -v152
    v_exp_f32 v152, v152
    v_exp_f32 v109, -v153
    v_exp_f32 v153, v153
    v_exp_f32 v110, -v154
    v_exp_f32 v154, v154
    v_exp_f32 v111, -v155
    v_exp_f32 v155, v155
K1_kv_common:
    s_nop 0
    v_pk_add_f32 v[4:5], v[124:125], v[126:127]
    v_pk_add_f32 v[6:7], v[80:81], v[82:83]
    v_pk_add_f32 v[4:5], v[4:5], v[128:129]
    v_pk_add_f32 v[6:7], v[6:7], v[84:85]
    v_pk_add_f32 v[4:5], v[4:5], v[130:131]
    v_pk_add_f32 v[6:7], v[6:7], v[86:87]
    v_pk_add_f32 v[4:5], v[4:5], v[132:133]
    v_pk_add_f32 v[6:7], v[6:7], v[88:89]
    v_pk_add_f32 v[4:5], v[4:5], v[134:135]
    v_pk_add_f32 v[6:7], v[6:7], v[90:91]
    v_pk_add_f32 v[4:5], v[4:5], v[136:137]
    v_pk_add_f32 v[6:7], v[6:7], v[92:93]
    v_pk_add_f32 v[4:5], v[4:5], v[138:139]
    v_pk_add_f32 v[6:7], v[6:7], v[94:95]
    v_pk_add_f32 v[8:9], v[140:141], v[142:143]
    v_pk_add_f32 v[10:11], v[96:97], v[98:99]
    v_pk_add_f32 v[8:9], v[8:9], v[144:145]
    v_pk_add_f32 v[10:11], v[10:11], v[100:101]
    v_pk_add_f32 v[8:9], v[8:9], v[146:147]
    v_pk_add_f32 v[10:11], v[10:11], v[102:103]
    v_pk_add_f32 v[8:9], v[8:9], v[148:149]
    v_pk_add_f32 v[10:11], v[10:11], v[104:105]
    v_pk_add_f32 v[8:9], v[8:9], v[150:151]
    v_pk_add_f32 v[10:11], v[10:11], v[106:107]
    v_pk_add_f32 v[8:9], v[8:9], v[152:153]
    v_pk_add_f32 v[10:11], v[10:11], v[108:109]
    v_pk_add_f32 v[8:9], v[8:9], v[154:155]
    v_pk_add_f32 v[10:11], v[10:11], v[110:111]
    v_add_f32 v4, v4, v5
    v_add_f32 v6, v6, v7
    v_add_f32 v8, v8, v9
    v_add_f32 v10, v10, v11
    v_permlane32_swap_b32 v4, v6
    s_nop 0
    v_permlane32_swap_b32 v8, v10
    v_add_f32 v4, v4, v6
    v_add_f32 v8, v8, v10
    v_rcp_f32 v4, v4
    v_rcp_f32 v8, v8
    v_mov_b32 v6, v4
    v_mov_b32 v10, v8
    s_nop 0
    v_permlane32_swap_b32 v4, v6
    v_permlane32_swap_b32 v8, v10
    v_pk_mul_f32 v[124:125], v[124:125], v[4:5] op_sel_hi:[1,0]
    v_pk_mul_f32 v[80:81], v[80:81], v[6:7] op_sel_hi:[1,0]
    v_pk_mul_f32 v[126:127], v[126:127], v[4:5] op_sel_hi:[1,0]
    v_pk_mul_f32 v[82:83], v[82:83], v[6:7] op_sel_hi:[1,0]
    v_cvt_pk_bf16_f32 v124, v124, v125
    v_cvt_pk_bf16_f32 v80, v80, v81
    v_cvt_pk_bf16_f32 v125, v126, v127
    v_cvt_pk_bf16_f32 v81, v82, v83
    ds_write_b64 v1, v[124:125] offset:0
    ds_write_b64 v1, v[80:81] offset:64
    v_pk_mul_f32 v[128:129], v[128:129], v[4:5] op_sel_hi:[1,0]
    v_pk_mul_f32 v[84:85], v[84:85], v[6:7] op_sel_hi:[1,0]
    v_pk_mul_f32 v[130:131], v[130:131], v[4:5] op_sel_hi:[1,0]
    v_pk_mul_f32 v[86:87], v[86:87], v[6:7] op_sel_hi:[1,0]
    v_cvt_pk_bf16_f32 v126, v128, v129
    v_cvt_pk_bf16_f32 v82, v84, v85
    v_cvt_pk_bf16_f32 v127, v130, v131
    v_cvt_pk_bf16_f32 v83, v86, v87
    ds_write_b64 v1, v[126:127] offset:16
    ds_write_b64 v1, v[82:83] offset:80
    v_pk_mul_f32 v[132:133], v[132:133], v[4:5] op_sel_hi:[1,0]
    v_pk_mul_f32 v[88:89], v[88:89], v[6:7] op_sel_hi:[1,0]
    v_pk_mul_f32 v[134:135], v[134:135], v[4:5] op_sel_hi:[1,0]
    v_pk_mul_f32 v[90:91], v[90:91], v[6:7] op_sel_hi:[1,0]
    v_cvt_pk_bf16_f32 v128, v132, v133
    v_cvt_pk_bf16_f32 v84, v88, v89
    v_cvt_pk_bf16_f32 v129, v134, v135
    v_cvt_pk_bf16_f32 v85, v90, v91
    ds_write_b64 v1, v[128:129] offset:32
    ds_write_b64 v1, v[84:85] offset:96
    v_pk_mul_f32 v[136:137], v[136:137], v[4:5] op_sel_hi:[1,0]
    v_pk_mul_f32 v[92:93], v[92:93], v[6:7] op_sel_hi:[1,0]
    v_pk_mul_f32 v[138:139], v[138:139], v[4:5] op_sel_hi:[1,0]
    v_pk_mul_f32 v[94:95], v[94:95], v[6:7] op_sel_hi:[1,0]
    v_cvt_pk_bf16_f32 v130, v136, v137
    v_cvt_pk_bf16_f32 v86, v92, v93
    v_cvt_pk_bf16_f32 v131, v138, v139
    v_cvt_pk_bf16_f32 v87, v94, v95
    ds_write_b64 v1, v[130:131] offset:48
    ds_write_b64 v1, v[86:87] offset:112
    v_pk_mul_f32 v[140:141], v[140:141], v[8:9] op_sel_hi:[1,0]
    v_pk_mul_f32 v[96:97], v[96:97], v[10:11] op_sel_hi:[1,0]
    v_pk_mul_f32 v[142:143], v[142:143], v[8:9] op_sel_hi:[1,0]
    v_pk_mul_f32 v[98:99], v[98:99], v[10:11] op_sel_hi:[1,0]
    v_cvt_pk_bf16_f32 v140, v140, v141
    v_cvt_pk_bf16_f32 v96, v96, v97
    v_cvt_pk_bf16_f32 v141, v142, v143
    v_cvt_pk_bf16_f32 v97, v98, v99
    ds_write_b64 v1, v[140:141] offset:4352
    ds_write_b64 v1, v[96:97] offset:4416
    v_pk_mul_f32 v[144:145], v[144:145], v[8:9] op_sel_hi:[1,0]
    v_pk_mul_f32 v[100:101], v[100:101], v[10:11] op_sel_hi:[1,0]
    v_pk_mul_f32 v[146:147], v[146:147], v[8:9] op_sel_hi:[1,0]
    v_pk_mul_f32 v[102:103], v[102:103], v[10:11] op_sel_hi:[1,0]
    v_cvt_pk_bf16_f32 v142, v144, v145
    v_cvt_pk_bf16_f32 v98, v100, v101
    v_cvt_pk_bf16_f32 v143, v146, v147
    v_cvt_pk_bf16_f32 v99, v102, v103
    ds_write_b64 v1, v[142:143] offset:4368
    ds_write_b64 v1, v[98:99] offset:4432
    v_pk_mul_f32 v[148:149], v[148:149], v[8:9] op_sel_hi:[1,0]
    v_pk_mul_f32 v[104:105], v[104:105], v[10:11] op_sel_hi:[1,0]
    v_pk_mul_f32 v[150:151], v[150:151], v[8:9] op_sel_hi:[1,0]
    v_pk_mul_f32 v[106:107], v[106:107], v[10:11] op_sel_hi:[1,0]
    v_cvt_pk_bf16_f32 v144, v148, v149
    v_cvt_pk_bf16_f32 v100, v104, v105
    v_cvt_pk_bf16_f32 v145, v150, v151
    v_cvt_pk_bf16_f32 v101, v106, v107
    ds_write_b64 v1, v[144:145] offset:4384
    ds_write_b64 v1, v[100:101] offset:4448
    v_pk_mul_f32 v[152:153], v[152:153], v[8:9] op_sel_hi:[1,0]
    v_pk_mul_f32 v[108:109], v[108:109], v[10:11] op_sel_hi:[1,0]
    v_pk_mul_f32 v[154:155], v[154:155], v[8:9] op_sel_hi:[1,0]
    v_pk_mul_f32 v[110:111], v[110:111], v[10:11] op_sel_hi:[1,0]
    v_cvt_pk_bf16_f32 v146, v152, v153
    v_cvt_pk_bf16_f32 v102, v108, v109
    v_cvt_pk_bf16_f32 v147, v154, v155
    v_cvt_pk_bf16_f32 v103, v110, v111
    ds_write_b64 v1, v[146:147] offset:4400
    ds_write_b64 v1, v[102:103] offset:4464
    s_waitcnt lgkmcnt(0)
    ds_read_b64_tr_b16 v[80:81], v2 offset:0
    ds_read_b64_tr_b16 v[82:83], v2 offset:1088
    ds_read_b64_tr_b16 v[84:85], v2 offset:2176
    ds_read_b64_tr_b16 v[86:87], v2 offset:3264
    ds_read_b64_tr_b16 v[88:89], v2 offset:4352
    ds_read_b64_tr_b16 v[90:91], v2 offset:5440
    ds_read_b64_tr_b16 v[92:93], v2 offset:6528
    ds_read_b64_tr_b16 v[94:95], v2 offset:7616
    ds_read_b64_tr_b16 v[96:97], v2 offset:64
    ds_read_b64_tr_b16 v[98:99], v2 offset:1152
    ds_read_b64_tr_b16 v[100:101], v2 offset:2240
    ds_read_b64_tr_b16 v[102:103], v2 offset:3328
    ds_read_b64_tr_b16 v[104:105], v2 offset:4416
    ds_read_b64_tr_b16 v[106:107], v2 offset:5504
    ds_read_b64_tr_b16 v[108:109], v2 offset:6592
    ds_read_b64_tr_b16 v[110:111], v2 offset:7680
    s_lshl_b32 s37, s36, 5
    s_lshl_b32 s3, s35, 1
    s_add_u32 s37, s37, s3
    s_add_u32 s37, s37, s38
    s_lshl_b32 s37, s37, 8
    s_add_u32 s37, s37, 17825792
    v_lshlrev_b32 v6, 2, v0
    v_lshlrev_b32 v1, 4, v0
    s_lshl_b32 s3, s39, 13
    s_add_u32 s3, s3, 122880
    v_add_u32 v2, s3, v1
    s_lshl_b32 s3, s36, 4
    s_add_u32 s3, s3, s35
    s_lshl_b32 s3, s3, 1
    s_add_u32 s3, s3, s38
    s_lshl_b32 s3, s3, 12
    s_add_u32 s3, s3, 13631488
    s_mov_b32 vcc_lo, 0
    s_mov_b32 vcc_hi, -1
    s_waitcnt lgkmcnt(14)
    v_mfma_f32_32x32x16_bf16 v[156:171], v[80:83], v[32:35], 0
    v_mfma_f32_16x16x32_bf16 v[112:115], v[120:123], v[80:83], 0
    s_waitcnt lgkmcnt(12)
    v_mfma_f32_32x32x16_bf16 v[156:171], v[84:87], v[36:39], v[156:171]
    v_mfma_f32_16x16x32_bf16 v[112:115], v[120:123], v[84:87], v[112:115]
    s_waitcnt lgkmcnt(10)
    v_mfma_f32_32x32x16_bf16 v[156:171], v[88:91], v[64:67], v[156:171]
    v_mfma_f32_16x16x32_bf16 v[112:115], v[120:123], v[88:91], v[112:115]
    s_waitcnt lgkmcnt(8)
    v_mfma_f32_32x32x16_bf16 v[156:171], v[92:95], v[68:71], v[156:171]
    v_mfma_f32_16x16x32_bf16 v[112:115], v[120:123], v[92:95], v[112:115]
    s_waitcnt lgkmcnt(6)
    v_mfma_f32_32x32x16_bf16 v[172:187], v[96:99], v[32:35], 0
    v_mfma_f32_16x16x32_bf16 v[116:119], v[120:123], v[96:99], 0
    s_waitcnt lgkmcnt(4)
    v_mfma_f32_32x32x16_bf16 v[172:187], v[100:103], v[36:39], v[172:187]
    v_mfma_f32_16x16x32_bf16 v[116:119], v[120:123], v[100:103], v[116:119]
    s_waitcnt lgkmcnt(2)
    v_mfma_f32_32x32x16_bf16 v[172:187], v[104:107], v[64:67], v[172:187]
    v_mfma_f32_16x16x32_bf16 v[116:119], v[120:123], v[104:107], v[116:119]
    s_waitcnt lgkmcnt(0)
    v_mfma_f32_32x32x16_bf16 v[172:187], v[108:111], v[68:71], v[172:187]
    v_mfma_f32_16x16x32_bf16 v[116:119], v[120:123], v[108:111], v[116:119]
    s_nop 7
    v_cndmask_b32 v4, v112, v116, vcc
    buffer_store_dword v4, v6, s[24:27], s37 offen sc1
    s_cmp_eq_u32 s38, 0
    s_nop 7
    s_cbranch_scc0 K1_kv_wm1
    ds_write_b128 v2, v[172:175] offset:4096
    ds_write_b128 v2, v[176:179] offset:5120
    ds_write_b128 v2, v[180:183] offset:6144
    ds_write_b128 v2, v[184:187] offset:7168
    s_waitcnt lgkmcnt(0)
    s_barrier
    ds_read_b128 v[80:83], v2 offset:0
    ds_read_b128 v[84:87], v2 offset:1024
    ds_read_b128 v[88:91], v2 offset:2048
    ds_read_b128 v[92:95], v2 offset:3072
    s_waitcnt lgkmcnt(3)
    v_pk_add_f32 v[156:157], v[156:157], v[80:81]
    v_pk_add_f32 v[158:159], v[158:159], v[82:83]
    buffer_store_dwordx4 v[156:159], v1, s[24:27], s3 offen offset:0 sc1
    s_waitcnt lgkmcnt(2)
    v_pk_add_f32 v[160:161], v[160:161], v[84:85]
    v_pk_add_f32 v[162:163], v[162:163], v[86:87]
    buffer_store_dwordx4 v[160:163], v1, s[24:27], s3 offen offset:1024 sc1
    s_waitcnt lgkmcnt(1)
    v_pk_add_f32 v[164:165], v[164:165], v[88:89]
    v_pk_add_f32 v[166:167], v[166:167], v[90:91]
    buffer_store_dwordx4 v[164:167], v1, s[24:27], s3 offen offset:2048 sc1
    s_waitcnt lgkmcnt(0)
    v_pk_add_f32 v[168:169], v[168:169], v[92:93]
    v_pk_add_f32 v[170:171], v[170:171], v[94:95]
    buffer_store_dwordx4 v[168:171], v1, s[24:27], s3 offen offset:3072 sc1
    s_endpgm
K1_kv_wm1:
    ds_write_b128 v2, v[156:159] offset:0
    ds_write_b128 v2, v[160:163] offset:1024
    ds_write_b128 v2, v[164:167] offset:2048
    ds_write_b128 v2, v[168:171] offset:3072
    s_waitcnt lgkmcnt(0)
    s_barrier
    ds_read_b128 v[80:83], v2 offset:4096
    ds_read_b128 v[84:87], v2 offset:5120
    ds_read_b128 v[88:91], v2 offset:6144
    ds_read_b128 v[92:95], v2 offset:7168
    s_waitcnt lgkmcnt(3)
    v_pk_add_f32 v[172:173], v[172:173], v[80:81]
    v_pk_add_f32 v[174:175], v[174:175], v[82:83]
    buffer_store_dwordx4 v[172:175], v1, s[24:27], s3 offen offset:0 sc1
    s_waitcnt lgkmcnt(2)
    v_pk_add_f32 v[176:177], v[176:177], v[84:85]
    v_pk_add_f32 v[178:179], v[178:179], v[86:87]
    buffer_store_dwordx4 v[176:179], v1, s[24:27], s3 offen offset:1024 sc1
    s_waitcnt lgkmcnt(1)
    v_pk_add_f32 v[180:181], v[180:181], v[88:89]
    v_pk_add_f32 v[182:183], v[182:183], v[90:91]
    buffer_store_dwordx4 v[180:183], v1, s[24:27], s3 offen offset:2048 sc1
    s_waitcnt lgkmcnt(0)
    v_pk_add_f32 v[184:185], v[184:185], v[92:93]
    v_pk_add_f32 v[186:187], v[186:187], v[94:95]
    buffer_store_dwordx4 v[184:187], v1, s[24:27], s3 offen offset:3072 sc1
    s_endpgm
K1_kv_slow:
    v_max3_f32 v4, v124, v125, v126
    v_min3_f32 v6, v124, v125, v126
    v_max3_f32 v4, v4, v127, v128
    v_min3_f32 v6, v6, v127, v128
    v_max3_f32 v4, v4, v129, v130
    v_min3_f32 v6, v6, v129, v130
    v_max3_f32 v4, v4, v131, v132
    v_min3_f32 v6, v6, v131, v132
    v_max3_f32 v4, v4, v133, v134
    v_min3_f32 v6, v6, v133, v134
    v_max3_f32 v4, v4, v135, v136
    v_min3_f32 v6, v6, v135, v136
    v_max3_f32 v4, v4, v137, v138
    v_min3_f32 v6, v6, v137, v138
    v_max_f32 v4, v4, v139
    v_min_f32 v6, v6, v139
    v_mov_b32 v8, v4
    v_mov_b32 v9, v6
    s_nop 0
    v_permlane32_swap_b32 v4, v8
    v_permlane32_swap_b32 v6, v9
    v_max_f32 v4, v4, v8
    v_min_f32 v6, v6, v9
    v_sub_f32 v80, v124, v6
    v_sub_f32 v124, v124, v4
    v_sub_f32 v81, v125, v6
    v_sub_f32 v125, v125, v4
    v_sub_f32 v82, v126, v6
    v_sub_f32 v126, v126, v4
    v_sub_f32 v83, v127, v6
    v_sub_f32 v127, v127, v4
    v_sub_f32 v84, v128, v6
    v_sub_f32 v128, v128, v4
    v_sub_f32 v85, v129, v6
    v_sub_f32 v129, v129, v4
    v_sub_f32 v86, v130, v6
    v_sub_f32 v130, v130, v4
    v_sub_f32 v87, v131, v6
    v_sub_f32 v131, v131, v4
    v_sub_f32 v88, v132, v6
    v_sub_f32 v132, v132, v4
    v_sub_f32 v89, v133, v6
    v_sub_f32 v133, v133, v4
    v_sub_f32 v90, v134, v6
    v_sub_f32 v134, v134, v4
    v_sub_f32 v91, v135, v6
    v_sub_f32 v135, v135, v4
    v_sub_f32 v92, v136, v6
    v_sub_f32 v136, v136, v4
    v_sub_f32 v93, v137, v6
    v_sub_f32 v137, v137, v4
    v_sub_f32 v94, v138, v6
    v_sub_f32 v138, v138, v4
    v_sub_f32 v95, v139, v6
    v_sub_f32 v139, v139, v4
    v_exp_f32 v80, -v80
    v_exp_f32 v124, v124
    v_exp_f32 v81, -v81
    v_exp_f32 v125, v125
    v_exp_f32 v82, -v82
    v_exp_f32 v126, v126
    v_exp_f32 v83, -v83
    v_exp_f32 v127, v127
    v_exp_f32 v84, -v84
    v_exp_f32 v128, v128
    v_exp_f32 v85, -v85
    v_exp_f32 v129, v129
    v_exp_f32 v86, -v86
    v_exp_f32 v130, v130
    v_exp_f32 v87, -v87
    v_exp_f32 v131, v131
    v_exp_f32 v88, -v88
    v_exp_f32 v132, v132
    v_exp_f32 v89, -v89
    v_exp_f32 v133, v133
    v_exp_f32 v90, -v90
    v_exp_f32 v134, v134
    v_exp_f32 v91, -v91
    v_exp_f32 v135, v135
    v_exp_f32 v92, -v92
    v_exp_f32 v136, v136
    v_exp_f32 v93, -v93
    v_exp_f32 v137, v137
    v_exp_f32 v94, -v94
    v_exp_f32 v138, v138
    v_exp_f32 v95, -v95
    v_exp_f32 v139, v139
    v_max3_f32 v4, v140, v141, v142
    v_min3_f32 v6, v140, v141, v142
    v_max3_f32 v4, v4, v143, v144
    v_min3_f32 v6, v6, v143, v144
    v_max3_f32 v4, v4, v145, v146
    v_min3_f32 v6, v6, v145, v146
    v_max3_f32 v4, v4, v147, v148
    v_min3_f32 v6, v6, v147, v148
    v_max3_f32 v4, v4, v149, v150
    v_min3_f32 v6, v6, v149, v150
    v_max3_f32 v4, v4, v151, v152
    v_min3_f32 v6, v6, v151, v152
    v_max3_f32 v4, v4, v153, v154
    v_min3_f32 v6, v6, v153, v154
    v_max_f32 v4, v4, v155
    v_min_f32 v6, v6, v155
    v_mov_b32 v8, v4
    v_mov_b32 v9, v6
    s_nop 0
    v_permlane32_swap_b32 v4, v8
    v_permlane32_swap_b32 v6, v9
    v_max_f32 v4, v4, v8
    v_min_f32 v6, v6, v9
    v_sub_f32 v96, v140, v6
    v_sub_f32 v140, v140, v4
    v_sub_f32 v97, v141, v6
    v_sub_f32 v141, v141, v4
    v_sub_f32 v98, v142, v6
    v_sub_f32 v142, v142, v4
    v_sub_f32 v99, v143, v6
    v_sub_f32 v143, v143, v4
    v_sub_f32 v100, v144, v6
    v_sub_f32 v144, v144, v4
    v_sub_f32 v101, v145, v6
    v_sub_f32 v145, v145, v4
    v_sub_f32 v102, v146, v6
    v_sub_f32 v146, v146, v4
    v_sub_f32 v103, v147, v6
    v_sub_f32 v147, v147, v4
    v_sub_f32 v104, v148, v6
    v_sub_f32 v148, v148, v4
    v_sub_f32 v105, v149, v6
    v_sub_f32 v149, v149, v4
    v_sub_f32 v106, v150, v6
    v_sub_f32 v150, v150, v4
    v_sub_f32 v107, v151, v6
    v_sub_f32 v151, v151, v4
    v_sub_f32 v108, v152, v6
    v_sub_f32 v152, v152, v4
    v_sub_f32 v109, v153, v6
    v_sub_f32 v153, v153, v4
    v_sub_f32 v110, v154, v6
    v_sub_f32 v154, v154, v4
    v_sub_f32 v111, v155, v6
    v_sub_f32 v155, v155, v4
    v_exp_f32 v96, -v96
    v_exp_f32 v140, v140
    v_exp_f32 v97, -v97
    v_exp_f32 v141, v141
    v_exp_f32 v98, -v98
    v_exp_f32 v142, v142
    v_exp_f32 v99, -v99
    v_exp_f32 v143, v143
    v_exp_f32 v100, -v100
    v_exp_f32 v144, v144
    v_exp_f32 v101, -v101
    v_exp_f32 v145, v145
    v_exp_f32 v102, -v102
    v_exp_f32 v146, v146
    v_exp_f32 v103, -v103
    v_exp_f32 v147, v147
    v_exp_f32 v104, -v104
    v_exp_f32 v148, v148
    v_exp_f32 v105, -v105
    v_exp_f32 v149, v149
    v_exp_f32 v106, -v106
    v_exp_f32 v150, v150
    v_exp_f32 v107, -v107
    v_exp_f32 v151, v151
    v_exp_f32 v108, -v108
    v_exp_f32 v152, v152
    v_exp_f32 v109, -v109
    v_exp_f32 v153, v153
    v_exp_f32 v110, -v110
    v_exp_f32 v154, v154
    v_exp_f32 v111, -v111
    v_exp_f32 v155, v155
    s_branch K1_kv_common
    s_endpgm
K1_T2:
    s_sub_u32 s3, s40, 12
    s_lshl_b32 s42, s3, 9
    s_add_u32 s37, s42, 256
    v_mul_u32_u24 v1, 2048, v1
    v_add_u32 v3, v3, v1
    s_lshl_b32 s3, s34, 8
    v_lshl_add_u32 v4, v0, 2, s3
    s_waitcnt lgkmcnt(0)
    s_mov_b32 s8, s52
    s_and_b32 s9, s53, 0xffff
    s_mov_b32 s10, 4194304
    s_mov_b32 s11, 0x00020000
    s_add_u32 s12, s54, s42
    s_addc_u32 s13, s55, 0
    s_sub_u32 s12, s12, 1024
    s_subb_u32 s13, s13, 0
    s_and_b32 s13, s13, 0xffff
    s_sub_u32 s14, 2098176, s42
    s_mov_b32 s15, 0x00020000
    s_add_u32 s16, s54, s37
    s_addc_u32 s17, s55, 0
    s_sub_u32 s16, s16, 2048
    s_subb_u32 s17, s17, 0
    s_and_b32 s17, s17, 0xffff
    s_sub_u32 s18, 2099200, s37
    s_mov_b32 s19, 0x00020000
    s_sub_u32 s20, s56, 3072
    s_subb_u32 s21, s57, 0
    s_and_b32 s21, s21, 0xffff
    s_mov_b32 s22, 68608
    s_mov_b32 s23, 0x00020000
    s_mov_b32 m0, s31
    s_add_u32 s31, s31, 26624
    buffer_load_dwordx4 v2, s[8:11], s28 offen lds
    buffer_load_dwordx4 v3, s[12:15], s29 offen offset:1024 lds
    buffer_load_dwordx4 v3, s[16:19], s29 offen offset:2048 lds
    buffer_load_dword v4, s[20:23], s30 offen offset:3072 lds
    s_add_u32 s30, s30, 2048
    s_add_u32 s28, s28, 64
    s_add_u32 s29, s29, 65536
    s_mov_b32 m0, s31
    s_add_u32 s31, s31, 26624
    buffer_load_dwordx4 v2, s[8:11], s28 offen lds
    buffer_load_dwordx4 v3, s[12:15], s29 offen offset:1024 lds
    buffer_load_dwordx4 v3, s[16:19], s29 offen offset:2048 lds
    buffer_load_dword v4, s[20:23], s30 offen offset:3072 lds
    s_add_u32 s30, s30, 2048
    s_add_u32 s28, s28, 64
    s_add_u32 s29, s29, 65536
    v_lshrrev_b32 v13, 5, v0
    s_lshr_b32 s38, s34, 2
    s_and_b32 s39, s34, 3
    v_and_b32 v10, 15, v0
    v_lshlrev_b32 v5, 6, v10
    v_bfe_u32 v11, v0, 4, 1
    v_mul_u32_u24 v15, 3328, v11
    v_add_u32 v5, v5, v15
    s_mul_i32 s3, s38, 13312
    v_add_u32 v5, s3, v5
    v_xor_b32 v7, v13, v12
    v_xor_b32 v15, 2, v7
    v_lshl_add_u32 v6, v15, 4, v5
    v_lshl_add_u32 v5, v7, 4, v5
    v_mul_u32_u24 v7, 6656, v13
    v_lshl_add_u32 v7, v12, 6, v7
    v_lshl_add_u32 v7, v11, 5, v7
    v_lshl_add_u32 v7, v14, 3, v7
    s_lshl_b32 s3, s39, 8
    s_add_u32 s3, s3, 1024
    v_add_u32 v7, s3, v7
    s_mov_b32 s32, 0
    s_mov_b32 s43, 0
    s_mov_b32 s65, 0
    s_mov_b32 s64, 4294834176
    v_mov_b32 v16, 0
    v_mov_b32 v17, 0
    v_mov_b32 v18, 0
    v_mov_b32 v19, 0
    v_mov_b32 v20, 0
    v_mov_b32 v21, 0
    v_mov_b32 v22, 0
    v_mov_b32 v23, 0
    v_mov_b32 v24, 0
    v_mov_b32 v25, 0
    v_mov_b32 v26, 0
    v_mov_b32 v27, 0
    v_mov_b32 v28, 0
    v_mov_b32 v29, 0
    v_mov_b32 v30, 0
    v_mov_b32 v31, 0
    v_mov_b32 v32, 0
    v_mov_b32 v33, 0
    v_mov_b32 v34, 0
    v_mov_b32 v35, 0
    v_mov_b32 v36, 0
    v_mov_b32 v37, 0
    v_mov_b32 v38, 0
    v_mov_b32 v39, 0
    v_mov_b32 v40, 0
    v_mov_b32 v41, 0
    v_mov_b32 v42, 0
    v_mov_b32 v43, 0
    v_mov_b32 v44, 0
    v_mov_b32 v45, 0
    v_mov_b32 v46, 0
    v_mov_b32 v47, 0
    v_mov_b32 v48, 0
    v_mov_b32 v49, 0
    v_mov_b32 v50, 0
    v_mov_b32 v51, 0
    v_mov_b32 v52, 0
    v_mov_b32 v53, 0
    v_mov_b32 v54, 0
    v_mov_b32 v55, 0
    v_mov_b32 v56, 0
    v_mov_b32 v57, 0
    v_mov_b32 v58, 0
    v_mov_b32 v59, 0
    v_mov_b32 v60, 0
    v_mov_b32 v61, 0
    v_mov_b32 v62, 0
    v_mov_b32 v63, 0
    v_mov_b32 v64, 0
    v_mov_b32 v65, 0
    v_mov_b32 v66, 0
    v_mov_b32 v67, 0
    v_mov_b32 v68, 0
    v_mov_b32 v69, 0
    v_mov_b32 v70, 0
    v_mov_b32 v71, 0
    v_mov_b32 v72, 0
    v_mov_b32 v73, 0
    v_mov_b32 v74, 0
    v_mov_b32 v75, 0
    v_mov_b32 v76, 0
    v_mov_b32 v77, 0
    v_mov_b32 v78, 0
    v_mov_b32 v79, 0
    s_mov_b32 s24, s60
    s_and_b32 s25, s61, 0xffff
    s_mov_b32 s26, 27267072
    s_mov_b32 s27, 0x00020000
    s_mul_i32 s3, s34, 3328
    v_lshrrev_b32 v8, 4, v0
    v_xor_b32 v8, v8, v12
    v_lshlrev_b32 v8, 4, v8
    v_lshl_add_u32 v8, v10, 6, v8
    v_add_u32 v8, s3, v8
    v_lshrrev_b32 v9, 4, v0
    v_mul_u32_u24 v9, 6656, v9
    v_lshl_add_u32 v9, v12, 6, v9
    v_lshl_add_u32 v9, v14, 3, v9
    s_and_b32 s3, s40, 1
    s_lshl_b32 s3, s3, 5
    s_add_u32 s3, s3, 3072
    v_add_u32 v9, s3, v9
    v_mov_b32 v120, 0
    v_mov_b32 v121, 0
    v_mov_b32 v122, 0
    v_mov_b32 v123, 0
    s_mov_b32 m0, s31
    s_add_u32 s31, s31, 26624
    buffer_load_dwordx4 v2, s[8:11], s28 offen lds
    buffer_load_dwordx4 v3, s[12:15], s29 offen offset:1024 lds
    buffer_load_dwordx4 v3, s[16:19], s29 offen offset:2048 lds
    buffer_load_dword v4, s[20:23], s30 offen offset:3072 lds
    s_add_u32 s30, s30, 2048
    s_add_u32 s28, s28, 64
    s_add_u32 s29, s29, 65536
    s_mov_b32 m0, s31
    s_add_u32 s31, s31, 26624
    buffer_load_dwordx4 v2, s[8:11], s28 offen lds
    buffer_load_dwordx4 v3, s[12:15], s29 offen offset:1024 lds
    buffer_load_dwordx4 v3, s[16:19], s29 offen offset:2048 lds
    buffer_load_dword v4, s[20:23], s30 offen offset:3072 lds
    s_add_u32 s30, s30, 2048
    s_add_u32 s28, s28, 64
    s_add_u32 s29, s29, 65536
    s_mov_b32 m0, s31
    s_add_u32 s31, s31, 26624
    buffer_load_dwordx4 v2, s[8:11], s28 offen lds
    buffer_load_dwordx4 v3, s[12:15], s29 offen offset:1024 lds
    buffer_load_dwordx4 v3, s[16:19], s29 offen offset:2048 lds
    buffer_load_dword v4, s[20:23], s30 offen offset:3072 lds
    s_add_u32 s30, s30, 2048
    s_add_u32 s28, s28, 64
    s_add_u32 s29, s29, 65536
    s_lshr_b32 s67, s34, 1
    s_add_u32 s69, s67, 2
    s_lshl_b32 s67, s67, 2
    s_sub_i32 s67, s67, 0
    s_max_i32 s67, s67, 0
    v_lshrrev_b32 v188, 1, v0
    v_lshlrev_b32 v188, 11, v188
    v_and_b32 v189, 1, v0
    v_lshl_add_u32 v188, v189, 7, v188
    s_lshr_b32 s3, s2, 6
    s_and_b32 s3, s3, 3
    s_lshl_b32 s3, s3, 5
    s_lshl_b32 s66, s35, 7
    s_add_u32 s3, s3, s66
    s_lshl_b32 s66, s3, 11
    s_lshl_b32 s3, s69, 8
    s_add_u32 s66, s66, s3
    s_mov_b32 s68, 1024
    s_bitcmp0_b32 s34, 0
    s_cbranch_scc1 rpf_3
    v_lshrrev_b32 v188, 2, v0
    v_mul_u32_u24 v188, 2048, v188
    v_lshl_add_u32 v188, v189, 7, v188
    v_bfe_u32 v189, v0, 1, 1
    v_mul_u32_u24 v189, 256, v189
    v_add_u32 v188, v188, v189
    s_and_b32 s3, s35, 7
    s_lshl_b32 s3, s3, 4
    s_lshl_b32 s66, s69, 7
    s_add_u32 s3, s3, s66
    s_mul_i32 s66, s3, 2048
    s_mov_b32 s68, 1048576
rpf_3:
    s_waitcnt vmcnt(16)
    s_barrier
    ds_read_b128 v[80:83], v5 offset:0
    ds_read_b64_tr_b16 v[88:89], v7 offset:0
    ds_read_b64_tr_b16 v[90:91], v7 offset:3328
    ds_read_b64_tr_b16 v[92:93], v7 offset:1024
    ds_read_b64_tr_b16 v[94:95], v7 offset:4352
    ds_read_b128 v[84:87], v5 offset:6656
.p2align 6
K1_T2_loop:
    s_waitcnt lgkmcnt(0)
    v_mfma_f32_32x32x16_bf16 v[16:31], v[88:91], v[80:83], v[16:31]
    ds_read_b128 v[96:99], v6 offset:0
    ds_read_b64_tr_b16 v[104:105], v7 offset:13312
    v_mfma_f32_32x32x16_bf16 v[32:47], v[92:95], v[80:83], v[32:47]
    ds_read_b64_tr_b16 v[106:107], v7 offset:16640
    ds_read_b64_tr_b16 v[108:109], v7 offset:14336
    v_mfma_f32_32x32x16_bf16 v[48:63], v[88:91], v[84:87], v[48:63]
    ds_read_b64_tr_b16 v[110:111], v7 offset:17664
    ds_read_b128 v[100:103], v6 offset:6656
    s_cmp_ge_u32 s32, 28
    v_mfma_f32_32x32x16_bf16 v[64:79], v[92:95], v[84:87], v[64:79]
    ds_read_b128 v[112:115], v8
    ds_read_b64_tr_b16 v[116:117], v9
    ds_read_b64_tr_b16 v[118:119], v9 offset:3328
    s_cbranch_scc1 K1_T2_loop_tw
    s_waitcnt vmcnt(12)
K1_T2_loop_back:
    s_barrier
    s_add_u32 s43, s43, 1
    s_cmp_eq_u32 s43, 6
    s_cselect_b32 s33, s64, 26624
    s_cselect_b32 s43, 0, s43
    s_waitcnt lgkmcnt(3)
    v_mfma_f32_32x32x16_bf16 v[16:31], v[104:107], v[96:99], v[16:31]
    v_add_u32 v5, s33, v5
    v_add_u32 v7, s33, v7
    ds_read_b128 v[80:83], v5 offset:0
    ds_read_b64_tr_b16 v[88:89], v7 offset:0
    v_mfma_f32_32x32x16_bf16 v[32:47], v[108:111], v[96:99], v[32:47]
    ds_read_b64_tr_b16 v[90:91], v7 offset:3328
    ds_read_b64_tr_b16 v[92:93], v7 offset:1024
    ds_read_b64_tr_b16 v[94:95], v7 offset:4352
    ds_read_b128 v[84:87], v5 offset:6656
    s_cmp_ge_u32 s32, 27
    v_mfma_f32_32x32x16_bf16 v[48:63], v[104:107], v[100:103], v[48:63]
    v_add_u32 v6, s33, v6
    s_cbranch_scc1 K1_T2_loop_nodma
    s_mov_b32 m0, s31
    s_add_u32 s31, s31, 26624
    buffer_load_dwordx4 v2, s[8:11], s28 offen lds
    buffer_load_dwordx4 v3, s[12:15], s29 offen offset:1024 lds
    buffer_load_dwordx4 v3, s[16:19], s29 offen offset:2048 lds
    buffer_load_dword v4, s[20:23], s30 offen offset:3072 lds
    s_add_u32 s30, s30, 2048
    s_add_u32 s28, s28, 64
    s_add_u32 s29, s29, 65536
    s_cmp_ge_u32 s31, s41
    s_cselect_b32 s3, 159744, 0
    s_sub_u32 s31, s31, s3
    s_cmp_eq_u32 s32, s67
    s_cbranch_scc1 K1_T2_loop_rpf
K1_T2_loop_nodma:
    s_waitcnt lgkmcnt(6)
    v_mfma_f32_16x16x32_bf16 v[120:123], v[116:119], v[112:115], v[120:123]
    v_add_u32 v8, s33, v8
    v_add_u32 v9, s33, v9
    s_add_u32 s32, s32, 1
    s_cmp_lt_u32 s32, 32
    v_mfma_f32_32x32x16_bf16 v[64:79], v[108:111], v[100:103], v[64:79]
    s_cbranch_scc1 K1_T2_loop
    s_branch K1_T2_loop_done
K1_T2_loop_tw:
    s_cmp_eq_u32 s32, 28
    s_cbranch_scc1 K1_T2_loop_tw2
    s_cmp_eq_u32 s32, 29
    s_cbranch_scc1 K1_T2_loop_tw1
    s_waitcnt vmcnt(0)
    s_branch K1_T2_loop_back
K1_T2_loop_tw2:
    s_waitcnt vmcnt(8)
    s_branch K1_T2_loop_back
K1_T2_loop_tw1:
    s_waitcnt vmcnt(4)
    s_branch K1_T2_loop_back
K1_T2_loop_rpf:
    s_bitcmp0_b32 s34, 0
    s_cbranch_scc1 K1_T2_loop_rpfx
    buffer_load_dword v190, v188, s[12:15], s66 offen offset:1024
    s_branch K1_T2_loop_rpfc
K1_T2_loop_rpfx:
    buffer_load_dword v190, v188, s[8:11], s66 offen
K1_T2_loop_rpfc:
    s_add_u32 s66, s66, s68
    s_add_u32 s69, s69, 4
    s_lshr_b32 s67, s34, 1
    s_lshl_b32 s67, s67, 2
    s_add_u32 s67, s67, 16
    s_cmp_ge_u32 s69, 8
    s_cselect_b32 s67, 99, s67
    s_branch K1_T2_loop_nodma
K1_T2_loop_done:
    s_nop 15
    s_waitcnt lgkmcnt(0)
    s_sub_u32 s3, s40, 12
    s_lshl_b32 s3, s3, 3
    s_add_u32 s3, s3, s39
    s_lshl_b32 s3, s3, 17
    s_lshl_b32 s36, s35, 13
    s_add_u32 s3, s3, s36
    s_lshl_b32 s36, s38, 12
    s_add_u32 s3, s3, s36
    s_add_u32 s3, s3, 8388608
    s_add_u32 s36, s3, 524288
    v_lshlrev_b32 v1, 4, v0
    v_cvt_pk_bf16_f32 v16, v16, v17
    v_cvt_pk_bf16_f32 v17, v18, v19
    v_cvt_pk_bf16_f32 v18, v20, v21
    v_cvt_pk_bf16_f32 v19, v22, v23
    v_cvt_pk_bf16_f32 v20, v24, v25
    v_cvt_pk_bf16_f32 v21, v26, v27
    v_cvt_pk_bf16_f32 v22, v28, v29
    v_cvt_pk_bf16_f32 v23, v30, v31
    buffer_store_dwordx4 v[16:19], v1, s[24:27], s3 offen offset:0 sc1
    buffer_store_dwordx4 v[20:23], v1, s[24:27], s3 offen offset:1024 sc1
    v_cvt_pk_bf16_f32 v32, v32, v33
    v_cvt_pk_bf16_f32 v33, v34, v35
    v_cvt_pk_bf16_f32 v34, v36, v37
    v_cvt_pk_bf16_f32 v35, v38, v39
    v_cvt_pk_bf16_f32 v36, v40, v41
    v_cvt_pk_bf16_f32 v37, v42, v43
    v_cvt_pk_bf16_f32 v38, v44, v45
    v_cvt_pk_bf16_f32 v39, v46, v47
    buffer_store_dwordx4 v[32:35], v1, s[24:27], s36 offen offset:0 sc1
    buffer_store_dwordx4 v[36:39], v1, s[24:27], s36 offen offset:1024 sc1
    v_cvt_pk_bf16_f32 v48, v48, v49
    v_cvt_pk_bf16_f32 v49, v50, v51
    v_cvt_pk_bf16_f32 v50, v52, v53
    v_cvt_pk_bf16_f32 v51, v54, v55
    v_cvt_pk_bf16_f32 v52, v56, v57
    v_cvt_pk_bf16_f32 v53, v58, v59
    v_cvt_pk_bf16_f32 v54, v60, v61
    v_cvt_pk_bf16_f32 v55, v62, v63
    buffer_store_dwordx4 v[48:51], v1, s[24:27], s3 offen offset:2048 sc1
    buffer_store_dwordx4 v[52:55], v1, s[24:27], s3 offen offset:3072 sc1
    v_cvt_pk_bf16_f32 v64, v64, v65
    v_cvt_pk_bf16_f32 v65, v66, v67
    v_cvt_pk_bf16_f32 v66, v68, v69
    v_cvt_pk_bf16_f32 v67, v70, v71
    v_cvt_pk_bf16_f32 v68, v72, v73
    v_cvt_pk_bf16_f32 v69, v74, v75
    v_cvt_pk_bf16_f32 v70, v76, v77
    v_cvt_pk_bf16_f32 v71, v78, v79
    buffer_store_dwordx4 v[64:67], v1, s[24:27], s36 offen offset:2048 sc1
    buffer_store_dwordx4 v[68:71], v1, s[24:27], s36 offen offset:3072 sc1
    v_mul_f32 v120, 0x3e8293ee, v120
    v_mul_f32 v121, 0x3e8293ee, v121
    v_mul_f32 v122, 0x3e8293ee, v122
    v_mul_f32 v123, 0x3e8293ee, v123
    v_cvt_pk_bf16_f32 v120, v120, v121
    v_cvt_pk_bf16_f32 v121, v122, v123
    v_bfe_u32 v2, v0, 4, 1
    v_lshlrev_b32 v2, 9, v2
    v_lshl_add_u32 v2, v10, 4, v2
    v_bfe_u32 v3, v0, 5, 1
    v_lshl_add_u32 v2, v3, 3, v2
    s_lshl_b32 s3, s35, 2
    s_lshr_b32 s36, s34, 1
    s_add_u32 s3, s3, s36
    s_lshl_b32 s3, s3, 12
    s_add_u32 s3, s3, 12582912
    s_and_b32 s36, s40, 1
    s_and_b32 s37, s34, 1
    s_lshl_b32 s36, s36, 10
    s_lshl_b32 s37, s37, 8
    s_add_u32 s3, s3, s36
    s_add_u32 s3, s3, s37
    v_permlane32_swap_b32 v120, v122
    v_permlane32_swap_b32 v121, v123
    s_mov_b32 exec_hi, 0
    buffer_store_dwordx4 v[120:123], v2, s[24:27], s3 offen sc1
    s_endpgm
K1_T3:
    s_sub_u32 s3, s40, 12
    s_lshl_b32 s42, s3, 9
    s_add_u32 s37, s42, 256
    v_mul_u32_u24 v1, 2048, v1
    v_add_u32 v3, v3, v1
    s_lshl_b32 s3, s34, 8
    v_lshl_add_u32 v4, v0, 2, s3
    s_waitcnt lgkmcnt(0)
    s_mov_b32 s8, s52
    s_and_b32 s9, s53, 0xffff
    s_mov_b32 s10, 4194304
    s_mov_b32 s11, 0x00020000
    s_add_u32 s12, s54, s42
    s_addc_u32 s13, s55, 0
    s_sub_u32 s12, s12, 1024
    s_subb_u32 s13, s13, 0
    s_and_b32 s13, s13, 0xffff
    s_sub_u32 s14, 2098176, s42
    s_mov_b32 s15, 0x00020000
    s_add_u32 s16, s54, s37
    s_addc_u32 s17, s55, 0
    s_sub_u32 s16, s16, 2048
    s_subb_u32 s17, s17, 0
    s_and_b32 s17, s17, 0xffff
    s_sub_u32 s18, 2099200, s37
    s_mov_b32 s19, 0x00020000
    s_sub_u32 s20, s58, 3072
    s_subb_u32 s21, s59, 0
    s_and_b32 s21, s21, 0xffff
    s_mov_b32 s22, 68608
    s_mov_b32 s23, 0x00020000
    s_mov_b32 m0, s31
    s_add_u32 s31, s31, 26624
    buffer_load_dwordx4 v2, s[8:11], s28 offen lds
    buffer_load_dwordx4 v3, s[12:15], s29 offen offset:1024 lds
    buffer_load_dwordx4 v3, s[16:19], s29 offen offset:2048 lds
    buffer_load_dword v4, s[20:23], s30 offen offset:3072 lds
    s_add_u32 s30, s30, 2048
    s_add_u32 s28, s28, 64
    s_add_u32 s29, s29, 65536
    s_mov_b32 m0, s31
    s_add_u32 s31, s31, 26624
    buffer_load_dwordx4 v2, s[8:11], s28 offen lds
    buffer_load_dwordx4 v3, s[12:15], s29 offen offset:1024 lds
    buffer_load_dwordx4 v3, s[16:19], s29 offen offset:2048 lds
    buffer_load_dword v4, s[20:23], s30 offen offset:3072 lds
    s_add_u32 s30, s30, 2048
    s_add_u32 s28, s28, 64
    s_add_u32 s29, s29, 65536
    v_lshrrev_b32 v13, 5, v0
    s_lshr_b32 s38, s34, 2
    s_and_b32 s39, s34, 3
    v_and_b32 v10, 15, v0
    v_lshlrev_b32 v5, 6, v10
    v_bfe_u32 v11, v0, 4, 1
    v_mul_u32_u24 v15, 3328, v11
    v_add_u32 v5, v5, v15
    s_mul_i32 s3, s38, 13312
    v_add_u32 v5, s3, v5
    v_xor_b32 v7, v13, v12
    v_xor_b32 v15, 2, v7
    v_lshl_add_u32 v6, v15, 4, v5
    v_lshl_add_u32 v5, v7, 4, v5
    v_mul_u32_u24 v7, 6656, v13
    v_lshl_add_u32 v7, v12, 6, v7
    v_lshl_add_u32 v7, v11, 5, v7
    v_lshl_add_u32 v7, v14, 3, v7
    s_lshl_b32 s3, s39, 8
    s_add_u32 s3, s3, 1024
    v_add_u32 v7, s3, v7
    s_mov_b32 s32, 0
    s_mov_b32 s43, 0
    s_mov_b32 s65, 0
    s_mov_b32 s64, 4294834176
    v_mov_b32 v16, 0
    v_mov_b32 v17, 0
    v_mov_b32 v18, 0
    v_mov_b32 v19, 0
    v_mov_b32 v20, 0
    v_mov_b32 v21, 0
    v_mov_b32 v22, 0
    v_mov_b32 v23, 0
    v_mov_b32 v24, 0
    v_mov_b32 v25, 0
    v_mov_b32 v26, 0
    v_mov_b32 v27, 0
    v_mov_b32 v28, 0
    v_mov_b32 v29, 0
    v_mov_b32 v30, 0
    v_mov_b32 v31, 0
    v_mov_b32 v32, 0
    v_mov_b32 v33, 0
    v_mov_b32 v34, 0
    v_mov_b32 v35, 0
    v_mov_b32 v36, 0
    v_mov_b32 v37, 0
    v_mov_b32 v38, 0
    v_mov_b32 v39, 0
    v_mov_b32 v40, 0
    v_mov_b32 v41, 0
    v_mov_b32 v42, 0
    v_mov_b32 v43, 0
    v_mov_b32 v44, 0
    v_mov_b32 v45, 0
    v_mov_b32 v46, 0
    v_mov_b32 v47, 0
    v_mov_b32 v48, 0
    v_mov_b32 v49, 0
    v_mov_b32 v50, 0
    v_mov_b32 v51, 0
    v_mov_b32 v52, 0
    v_mov_b32 v53, 0
    v_mov_b32 v54, 0
    v_mov_b32 v55, 0
    v_mov_b32 v56, 0
    v_mov_b32 v57, 0
    v_mov_b32 v58, 0
    v_mov_b32 v59, 0
    v_mov_b32 v60, 0
    v_mov_b32 v61, 0
    v_mov_b32 v62, 0
    v_mov_b32 v63, 0
    v_mov_b32 v64, 0
    v_mov_b32 v65, 0
    v_mov_b32 v66, 0
    v_mov_b32 v67, 0
    v_mov_b32 v68, 0
    v_mov_b32 v69, 0
    v_mov_b32 v70, 0
    v_mov_b32 v71, 0
    v_mov_b32 v72, 0
    v_mov_b32 v73, 0
    v_mov_b32 v74, 0
    v_mov_b32 v75, 0
    v_mov_b32 v76, 0
    v_mov_b32 v77, 0
    v_mov_b32 v78, 0
    v_mov_b32 v79, 0
    s_mov_b32 s24, s60
    s_and_b32 s25, s61, 0xffff
    s_mov_b32 s26, 27267072
    s_mov_b32 s27, 0x00020000
    s_mul_i32 s3, s34, 3328
    v_lshrrev_b32 v8, 4, v0
    v_xor_b32 v8, v8, v12
    v_lshlrev_b32 v8, 4, v8
    v_lshl_add_u32 v8, v10, 6, v8
    v_add_u32 v8, s3, v8
    v_lshrrev_b32 v9, 4, v0
    v_mul_u32_u24 v9, 6656, v9
    v_lshl_add_u32 v9, v12, 6, v9
    v_lshl_add_u32 v9, v14, 3, v9
    s_and_b32 s3, s40, 1
    s_lshl_b32 s3, s3, 5
    s_add_u32 s3, s3, 3072
    v_add_u32 v9, s3, v9
    v_mov_b32 v120, 0
    v_mov_b32 v121, 0
    v_mov_b32 v122, 0
    v_mov_b32 v123, 0
    s_mov_b32 m0, s31
    s_add_u32 s31, s31, 26624
    buffer_load_dwordx4 v2, s[8:11], s28 offen lds
    buffer_load_dwordx4 v3, s[12:15], s29 offen offset:1024 lds
    buffer_load_dwordx4 v3, s[16:19], s29 offen offset:2048 lds
    buffer_load_dword v4, s[20:23], s30 offen offset:3072 lds
    s_add_u32 s30, s30, 2048
    s_add_u32 s28, s28, 64
    s_add_u32 s29, s29, 65536
    s_mov_b32 m0, s31
    s_add_u32 s31, s31, 26624
    buffer_load_dwordx4 v2, s[8:11], s28 offen lds
    buffer_load_dwordx4 v3, s[12:15], s29 offen offset:1024 lds
    buffer_load_dwordx4 v3, s[16:19], s29 offen offset:2048 lds
    buffer_load_dword v4, s[20:23], s30 offen offset:3072 lds
    s_add_u32 s30, s30, 2048
    s_add_u32 s28, s28, 64
    s_add_u32 s29, s29, 65536
    s_mov_b32 m0, s31
    s_add_u32 s31, s31, 26624
    buffer_load_dwordx4 v2, s[8:11], s28 offen lds
    buffer_load_dwordx4 v3, s[12:15], s29 offen offset:1024 lds
    buffer_load_dwordx4 v3, s[16:19], s29 offen offset:2048 lds
    buffer_load_dword v4, s[20:23], s30 offen offset:3072 lds
    s_add_u32 s30, s30, 2048
    s_add_u32 s28, s28, 64
    s_add_u32 s29, s29, 65536
    s_lshr_b32 s67, s34, 1
    s_add_u32 s69, s67, 2
    s_lshl_b32 s67, s67, 2
    s_sub_i32 s67, s67, 0
    s_max_i32 s67, s67, 0
    v_lshrrev_b32 v188, 1, v0
    v_lshlrev_b32 v188, 11, v188
    v_and_b32 v189, 1, v0
    v_lshl_add_u32 v188, v189, 7, v188
    s_lshr_b32 s3, s2, 6
    s_and_b32 s3, s3, 3
    s_lshl_b32 s3, s3, 5
    s_lshl_b32 s66, s35, 7
    s_add_u32 s3, s3, s66
    s_lshl_b32 s66, s3, 11
    s_lshl_b32 s3, s69, 8
    s_add_u32 s66, s66, s3
    s_mov_b32 s68, 1024
    s_bitcmp0_b32 s34, 0
    s_cbranch_scc1 rpf_4
    v_lshrrev_b32 v188, 2, v0
    v_mul_u32_u24 v188, 2048, v188
    v_lshl_add_u32 v188, v189, 7, v188
    v_bfe_u32 v189, v0, 1, 1
    v_mul_u32_u24 v189, 256, v189
    v_add_u32 v188, v188, v189
    s_and_b32 s3, s35, 7
    s_lshl_b32 s3, s3, 4
    s_lshl_b32 s66, s69, 7
    s_add_u32 s3, s3, s66
    s_mul_i32 s66, s3, 2048
    s_mov_b32 s68, 1048576
rpf_4:
    s_waitcnt vmcnt(16)
    s_barrier
    ds_read_b128 v[80:83], v5 offset:0
    ds_read_b64_tr_b16 v[88:89], v7 offset:0
    ds_read_b64_tr_b16 v[90:91], v7 offset:3328
    ds_read_b64_tr_b16 v[92:93], v7 offset:1024
    ds_read_b64_tr_b16 v[94:95], v7 offset:4352
    ds_read_b128 v[84:87], v5 offset:6656
.p2align 6
K1_T3_loop:
    s_waitcnt lgkmcnt(0)
    v_mfma_f32_32x32x16_bf16 v[16:31], v[88:91], v[80:83], v[16:31]
    ds_read_b128 v[96:99], v6 offset:0
    ds_read_b64_tr_b16 v[104:105], v7 offset:13312
    v_mfma_f32_32x32x16_bf16 v[32:47], v[92:95], v[80:83], v[32:47]
    ds_read_b64_tr_b16 v[106:107], v7 offset:16640
    ds_read_b64_tr_b16 v[108:109], v7 offset:14336
    v_mfma_f32_32x32x16_bf16 v[48:63], v[88:91], v[84:87], v[48:63]
    ds_read_b64_tr_b16 v[110:111], v7 offset:17664
    ds_read_b128 v[100:103], v6 offset:6656
    s_cmp_ge_u32 s32, 28
    v_mfma_f32_32x32x16_bf16 v[64:79], v[92:95], v[84:87], v[64:79]
    ds_read_b128 v[112:115], v8
    ds_read_b64_tr_b16 v[116:117], v9
    ds_read_b64_tr_b16 v[118:119], v9 offset:3328
    s_cbranch_scc1 K1_T3_loop_tw
    s_waitcnt vmcnt(12)
K1_T3_loop_back:
    s_barrier
    s_add_u32 s43, s43, 1
    s_cmp_eq_u32 s43, 6
    s_cselect_b32 s33, s64, 26624
    s_cselect_b32 s43, 0, s43
    s_waitcnt lgkmcnt(3)
    v_mfma_f32_32x32x16_bf16 v[16:31], v[104:107], v[96:99], v[16:31]
    v_add_u32 v5, s33, v5
    v_add_u32 v7, s33, v7
    ds_read_b128 v[80:83], v5 offset:0
    ds_read_b64_tr_b16 v[88:89], v7 offset:0
    v_mfma_f32_32x32x16_bf16 v[32:47], v[108:111], v[96:99], v[32:47]
    ds_read_b64_tr_b16 v[90:91], v7 offset:3328
    ds_read_b64_tr_b16 v[92:93], v7 offset:1024
    ds_read_b64_tr_b16 v[94:95], v7 offset:4352
    ds_read_b128 v[84:87], v5 offset:6656
    s_cmp_ge_u32 s32, 27
    v_mfma_f32_32x32x16_bf16 v[48:63], v[104:107], v[100:103], v[48:63]
    v_add_u32 v6, s33, v6
    s_cbranch_scc1 K1_T3_loop_nodma
    s_mov_b32 m0, s31
    s_add_u32 s31, s31, 26624
    buffer_load_dwordx4 v2, s[8:11], s28 offen lds
    buffer_load_dwordx4 v3, s[12:15], s29 offen offset:1024 lds
    buffer_load_dwordx4 v3, s[16:19], s29 offen offset:2048 lds
    buffer_load_dword v4, s[20:23], s30 offen offset:3072 lds
    s_add_u32 s30, s30, 2048
    s_add_u32 s28, s28, 64
    s_add_u32 s29, s29, 65536
    s_cmp_ge_u32 s31, s41
    s_cselect_b32 s3, 159744, 0
    s_sub_u32 s31, s31, s3
    s_cmp_eq_u32 s32, s67
    s_cbranch_scc1 K1_T3_loop_rpf
K1_T3_loop_nodma:
    s_waitcnt lgkmcnt(6)
    v_mfma_f32_16x16x32_bf16 v[120:123], v[112:115], v[116:119], v[120:123]
    v_add_u32 v8, s33, v8
    v_add_u32 v9, s33, v9
    s_add_u32 s32, s32, 1
    s_cmp_lt_u32 s32, 32
    v_mfma_f32_32x32x16_bf16 v[64:79], v[108:111], v[100:103], v[64:79]
    s_cbranch_scc1 K1_T3_loop
    s_branch K1_T3_loop_done
K1_T3_loop_tw:
    s_cmp_eq_u32 s32, 28
    s_cbranch_scc1 K1_T3_loop_tw2
    s_cmp_eq_u32 s32, 29
    s_cbranch_scc1 K1_T3_loop_tw1
    s_waitcnt vmcnt(0)
    s_branch K1_T3_loop_back
K1_T3_loop_tw2:
    s_waitcnt vmcnt(8)
    s_branch K1_T3_loop_back
K1_T3_loop_tw1:
    s_waitcnt vmcnt(4)
    s_branch K1_T3_loop_back
K1_T3_loop_rpf:
    s_bitcmp0_b32 s34, 0
    s_cbranch_scc1 K1_T3_loop_rpfx
    buffer_load_dword v190, v188, s[12:15], s66 offen offset:1024
    s_branch K1_T3_loop_rpfc
K1_T3_loop_rpfx:
    buffer_load_dword v190, v188, s[8:11], s66 offen
K1_T3_loop_rpfc:
    s_add_u32 s66, s66, s68
    s_add_u32 s69, s69, 4
    s_lshr_b32 s67, s34, 1
    s_lshl_b32 s67, s67, 2
    s_add_u32 s67, s67, 16
    s_cmp_ge_u32 s69, 8
    s_cselect_b32 s67, 99, s67
    s_branch K1_T3_loop_nodma
K1_T3_loop_done:
    s_nop 15
    s_waitcnt lgkmcnt(0)
    s_sub_u32 s3, s40, 12
    s_lshl_b32 s3, s3, 3
    s_add_u32 s3, s3, s39
    s_lshl_b32 s3, s3, 17
    s_lshl_b32 s36, s35, 13
    s_add_u32 s3, s3, s36
    s_lshl_b32 s36, s38, 12
    s_add_u32 s3, s3, s36
    s_add_u32 s3, s3, 8388608
    s_add_u32 s36, s3, 524288
    v_lshlrev_b32 v1, 4, v0
    v_cvt_pk_bf16_f32 v16, v16, v17
    v_cvt_pk_bf16_f32 v17, v18, v19
    v_cvt_pk_bf16_f32 v18, v20, v21
    v_cvt_pk_bf16_f32 v19, v22, v23
    v_cvt_pk_bf16_f32 v20, v24, v25
    v_cvt_pk_bf16_f32 v21, v26, v27
    v_cvt_pk_bf16_f32 v22, v28, v29
    v_cvt_pk_bf16_f32 v23, v30, v31
    buffer_store_dwordx4 v[16:19], v1, s[24:27], s3 offen offset:0 sc1
    buffer_store_dwordx4 v[20:23], v1, s[24:27], s3 offen offset:1024 sc1
    v_cvt_pk_bf16_f32 v32, v32, v33
    v_cvt_pk_bf16_f32 v33, v34, v35
    v_cvt_pk_bf16_f32 v34, v36, v37
    v_cvt_pk_bf16_f32 v35, v38, v39
    v_cvt_pk_bf16_f32 v36, v40, v41
    v_cvt_pk_bf16_f32 v37, v42, v43
    v_cvt_pk_bf16_f32 v38, v44, v45
    v_cvt_pk_bf16_f32 v39, v46, v47
    buffer_store_dwordx4 v[32:35], v1, s[24:27], s36 offen offset:0 sc1
    buffer_store_dwordx4 v[36:39], v1, s[24:27], s36 offen offset:1024 sc1
    v_cvt_pk_bf16_f32 v48, v48, v49
    v_cvt_pk_bf16_f32 v49, v50, v51
    v_cvt_pk_bf16_f32 v50, v52, v53
    v_cvt_pk_bf16_f32 v51, v54, v55
    v_cvt_pk_bf16_f32 v52, v56, v57
    v_cvt_pk_bf16_f32 v53, v58, v59
    v_cvt_pk_bf16_f32 v54, v60, v61
    v_cvt_pk_bf16_f32 v55, v62, v63
    buffer_store_dwordx4 v[48:51], v1, s[24:27], s3 offen offset:2048 sc1
    buffer_store_dwordx4 v[52:55], v1, s[24:27], s3 offen offset:3072 sc1
    v_cvt_pk_bf16_f32 v64, v64, v65
    v_cvt_pk_bf16_f32 v65, v66, v67
    v_cvt_pk_bf16_f32 v66, v68, v69
    v_cvt_pk_bf16_f32 v67, v70, v71
    v_cvt_pk_bf16_f32 v68, v72, v73
    v_cvt_pk_bf16_f32 v69, v74, v75
    v_cvt_pk_bf16_f32 v70, v76, v77
    v_cvt_pk_bf16_f32 v71, v78, v79
    buffer_store_dwordx4 v[64:67], v1, s[24:27], s36 offen offset:2048 sc1
    buffer_store_dwordx4 v[68:71], v1, s[24:27], s36 offen offset:3072 sc1
    v_cvt_pk_bf16_f32 v120, v120, v121
    v_cvt_pk_bf16_f32 v121, v122, v123
    v_bfe_u32 v2, v0, 5, 1
    v_lshlrev_b32 v2, 9, v2
    v_lshl_add_u32 v2, v10, 4, v2
    v_bfe_u32 v3, v0, 4, 1
    v_lshl_add_u32 v2, v3, 3, v2
    s_lshl_b32 s3, s35, 2
    s_lshr_b32 s36, s34, 1
    s_add_u32 s3, s3, s36
    s_lshl_b32 s3, s3, 12
    s_add_u32 s3, s3, 12584960
    s_and_b32 s36, s40, 1
    s_and_b32 s37, s34, 1
    s_lshl_b32 s37, s37, 10
    s_lshl_b32 s36, s36, 8
    s_add_u32 s3, s3, s36
    s_add_u32 s3, s3, s37
    v_permlane16_swap_b32 v120, v122
    v_permlane16_swap_b32 v121, v123
    s_mov_b32 exec_lo, 0xffff
    s_mov_b32 exec_hi, 0xffff
    buffer_store_dwordx4 v[120:123], v2, s[24:27], s3 offen sc1
    s_mov_b64 exec, -1
    s_or_b32 s3, s35, s34
    s_sub_u32 s36, s40, 15
    s_or_b32 s3, s3, s36
    s_cmp_lg_u32 s3, 0
    s_cbranch_scc1 K1_nofl
    v_mov_b32 v4, 0
    v_mov_b32 v5, 0
    v_mov_b32 v6, 0
    v_mov_b32 v7, 0
    s_mov_b32 s3, 27262976
    buffer_store_dwordx4 v[4:7], v1, s[24:27], s3 offen sc1
    buffer_store_dwordx4 v[4:7], v1, s[24:27], s3 offen offset:1024 sc1
K1_nofl:
    s_endpgm
K1_end:
    s_endpgm
.text
.globl k2_kernel
.p2align 8
.type k2_kernel,@function
k2_kernel:
    s_cmp_ge_u32 s2, 256
    s_cbranch_scc1 K2_end
    s_load_dwordx2 s[60:61], s[0:1], 88
    s_load_dwordx2 s[44:45], s[0:1], 24
    s_load_dwordx2 s[46:47], s[0:1], 64
    v_lshrrev_b32 v1, 6, v0
    v_and_b32 v0, 63, v0
    v_readfirstlane_b32 s34, v1
    s_and_b32 s3, s2, 7
    s_lshr_b32 s36, s2, 3
    s_load_dwordx2 s[88:89], s[0:1], 24
    s_load_dwordx4 s[92:95], s[0:1], 64
    s_lshr_b32 s35, s3, 1
    s_lshl_b32 s35, s35, 3
    s_lshr_b32 s37, s36, 2
    s_add_u32 s35, s35, s37
    s_and_b32 s3, s3, 1
    s_lshl_b32 s3, s3, 2
    s_and_b32 s36, s36, 3
    s_add_u32 s36, s36, s3
    s_lshl_b32 s36, s36, 3
    v_lshlrev_b32 v1, 4, v0
    s_add_u32 s36, s36, s34
    s_lshl_b32 s31, s34, 12
    s_add_u32 s28, s31, 12582912
    s_lshl_b32 s38, s35, 17
    s_lshl_b32 s39, s36, 11
    s_add_u32 s38, s38, s39
    s_add_u32 s39, s38, 8388608
    s_lshl_b32 s38, s38, 1
    s_mov_b32 s26, 27267072
    s_mov_b32 s27, 0x00020000
    s_mov_b32 m0, s31
    s_waitcnt lgkmcnt(0)
    s_mov_b32 s24, s60
    s_and_b32 s25, s61, 0xffff
    buffer_load_dwordx4 v1, s[24:27], s28 offen offset:0 lds
    buffer_load_dwordx4 v1, s[24:27], s28 offen offset:1024 lds
    buffer_load_dwordx4 v1, s[24:27], s28 offen offset:2048 lds
    buffer_load_dwordx4 v1, s[24:27], s28 offen offset:3072 lds
    buffer_load_dwordx4 v[8:11], v1, s[24:27], s39 offen
    buffer_load_dwordx4 v[12:15], v1, s[24:27], s39 offen offset:1024
    s_lshl_b32 s37, s34, 10
    s_lshl_b32 s57, s35, 13
    s_add_u32 s57, s57, s37
    s_add_u32 s57, s57, 17825792
    s_lshl_b32 s68, s35, 17
    s_add_u32 s68, s68, s37
    s_add_u32 s68, s68, 13631488
    s_movk_i32 s69, 8192
    v_lshlrev_b32 v2, 2, v0
    v_lshrrev_b32 v7, 5, v0
    v_lshrrev_b32 v3, 2, v0
    v_xor_b32 v3, v3, v0
    v_and_b32 v3, 4, v3
    v_and_b32 v4, 3, v0
    v_or_b32 v3, v3, v4
    v_cmp_eq_u32 vcc, 0, v3
    v_cmp_eq_u32 s[66:67], 1, v3
    v_mov_b32 v4, 0x3f803f80
    v_mov_b32 v5, 0
    v_cndmask_b32 v108, v5, v4, vcc
    v_cndmask_b32 v109, v5, v4, vcc
    v_cndmask_b32 v110, v5, v4, vcc
    v_cndmask_b32 v111, v5, v4, vcc
    v_mov_b32 v88, 0
    v_mov_b32 v112, 0
    v_mov_b32 v89, 0
    v_mov_b32 v113, 0
    v_mov_b32 v90, 0
    v_mov_b32 v114, 0
    v_mov_b32 v91, 0
    v_mov_b32 v115, 0
    v_mov_b32 v92, 0
    v_mov_b32 v116, 0
    v_mov_b32 v93, 0
    v_mov_b32 v117, 0
    v_mov_b32 v94, 0
    v_mov_b32 v118, 0
    v_mov_b32 v95, 0
    v_mov_b32 v119, 0
    v_mov_b32 v96, 0
    v_mov_b32 v120, 0
    v_mov_b32 v97, 0
    v_mov_b32 v121, 0
    v_mov_b32 v98, 0
    v_mov_b32 v122, 0
    v_mov_b32 v99, 0
    v_mov_b32 v123, 0
    v_mov_b32 v100, 0
    v_mov_b32 v124, 0
    v_mov_b32 v101, 0
    v_mov_b32 v125, 0
    v_mov_b32 v102, 0
    v_mov_b32 v126, 0
    v_mov_b32 v103, 0
    v_mov_b32 v127, 0
    v_mov_b32 v104, 0
    v_mov_b32 v56, 0
    v_mov_b32 v60, 0
    v_mov_b32 v28, 0
    v_mov_b32 v128, 0
    v_mov_b32 v105, 0
    v_mov_b32 v57, 0
    v_mov_b32 v61, 0
    v_mov_b32 v29, 0
    v_mov_b32 v129, 0
    v_mov_b32 v106, 0
    v_mov_b32 v58, 0
    v_mov_b32 v62, 0
    v_mov_b32 v30, 0
    v_mov_b32 v130, 0
    v_mov_b32 v107, 0
    v_mov_b32 v59, 0
    v_mov_b32 v63, 0
    v_mov_b32 v31, 0
    v_mov_b32 v131, 0
    v_and_b32 v3, 7, v0
    v_cmp_eq_u32 vcc, 0, v3
    v_mov_b32 v84, 0xdddddddd
    s_nop 0
    v_cndmask_b32 v80, v5, v4, vcc
    v_cndmask_b32 v81, v5, v4, vcc
    v_cmp_eq_u32 vcc, 4, v3
    s_nop 1
    v_cndmask_b32 v82, v5, v4, vcc
    v_cndmask_b32 v83, v5, v4, vcc
    v_and_b32 v6, 15, v0
    v_lshlrev_b32 v6, 4, v6
    v_lshrrev_b32 v3, 4, v0
    v_lshl_add_u32 v6, v3, 2, v6
    s_lshl_b32 s3, s34, 8
    s_add_u32 s3, s3, 135168
    v_add_u32 v6, s3, v6
    s_and_b32 s55, s34, 3
    s_cmp_lt_u32 s2, 128
    s_cselect_b32 s44, s44, s46
    s_cselect_b32 s45, s45, s47
    s_mov_b32 s48, s44
    s_and_b32 s49, s45, 0xffff
    s_mov_b32 s50, 2097152
    s_mov_b32 s51, 0x00020000
    s_and_b32 s3, s2, 127
    s_lshl_b32 s3, s3, 14
    s_lshl_b32 s37, s34, 11
    s_add_u32 s52, s3, s37
    s_mov_b32 s32, 0
    s_lshr_b32 s3, s34, 1
    s_lshl_b32 s3, s3, 10
    s_and_b32 s37, s34, 1
    s_lshl_b32 s37, s37, 3
    s_add_u32 s3, s3, s37
    s_add_u32 s53, s3, 131072
    s_lshl_b32 s40, s36, 16
    s_lshl_b32 s3, s35, 11
    s_add_u32 s40, s40, s3
    s_add_u32 s41, s40, 23068672
    s_add_u32 s40, s40, 18874368
    v_mov_b32 v5, v1
    v_add_u32 v4, 32768, v1
    s_add_u32 s31, s31, 32768
    s_add_u32 s28, s28, 32768
    s_and_b32 s31, s31, 131071
    s_mov_b32 m0, s31
    s_nop 0
    buffer_load_dwordx4 v1, s[24:27], s28 offen offset:0 lds
    buffer_load_dwordx4 v1, s[24:27], s28 offen offset:1024 lds
    buffer_load_dwordx4 v1, s[24:27], s28 offen offset:2048 lds
    buffer_load_dwordx4 v1, s[24:27], s28 offen offset:3072 lds
    s_waitcnt vmcnt(4)
    s_barrier
    s_add_u32 s31, s31, 32768
    s_add_u32 s28, s28, 32768
    s_and_b32 s31, s31, 131071
    s_mov_b32 m0, s31
    s_nop 0
    buffer_load_dwordx4 v1, s[24:27], s28 offen offset:0 lds
    buffer_load_dwordx4 v1, s[24:27], s28 offen offset:1024 lds
    buffer_load_dwordx4 v1, s[24:27], s28 offen offset:2048 lds
    buffer_load_dwordx4 v1, s[24:27], s28 offen offset:3072 lds
    buffer_load_dwordx4 v[132:135], v1, s[24:27], s57 offen
    ds_read_b128 v[16:19], v5
    ds_read_b128 v[20:23], v5 offset:1024
    ds_read_b128 v[24:27], v5 offset:2048
    s_waitcnt lgkmcnt(2)
    v_mfma_f32_32x32x16_bf16 v[32:47], v[16:19], v[8:11], 0
    s_waitcnt lgkmcnt(1)
    v_mfma_f32_32x32x16_bf16 v[32:47], v[20:23], v[12:15], v[32:47]
    ds_read_b128 v[16:19], v5 offset:4096
    ds_read_b128 v[20:23], v5 offset:5120
    s_nop 9
    v_max3_f32 v208, v32, v33, v34
    v_max3_f32 v208, v208, v35, v36
    v_max3_f32 v208, v208, v37, v38
    v_max3_f32 v208, v208, v39, v40
    v_max3_f32 v208, v208, v41, v42
    v_max3_f32 v208, v208, v43, v44
    v_max3_f32 v208, v208, v45, v46
    v_max_f32 v208, v208, v47
    v_mov_b32 v209, v208
    s_nop 1
    v_permlane32_swap_b32 v208, v209
    v_max_f32 v208, v208, v209
    v_sub_f32 v64, 0, v208
    v_mov_b32 v65, v64
    v_mov_b32 v66, v64
    v_mov_b32 v67, v64
    v_mov_b32 v68, v64
    v_mov_b32 v69, v64
    v_mov_b32 v70, v64
    v_mov_b32 v71, v64
    v_mov_b32 v72, v64
    v_mov_b32 v73, v64
    v_mov_b32 v74, v64
    v_mov_b32 v75, v64
    v_mov_b32 v76, v64
    v_mov_b32 v77, v64
    v_mov_b32 v78, v64
    v_mov_b32 v79, v64
    v_pk_add_f32 v[32:33], v[32:33], v[64:65]
    v_pk_add_f32 v[34:35], v[34:35], v[64:65]
    v_pk_add_f32 v[36:37], v[36:37], v[64:65]
    v_pk_add_f32 v[38:39], v[38:39], v[64:65]
    v_pk_add_f32 v[40:41], v[40:41], v[64:65]
    v_pk_add_f32 v[42:43], v[42:43], v[64:65]
    v_pk_add_f32 v[44:45], v[44:45], v[64:65]
    v_pk_add_f32 v[46:47], v[46:47], v[64:65]
    s_waitcnt lgkmcnt(0)
.p2align 6
K2_chunk:
    s_setprio 3
    s_sub_u32 s3, s32, 1
    s_cmp_ge_u32 s3, 5
    s_cbranch_scc1 K2_wA
    s_waitcnt vmcnt(8) lgkmcnt(0)
K2_bar:
    s_barrier
K2_go:
    s_cmp_eq_u32 s32, 4
    s_cselect_b64 vcc, -1, 0
    s_cselect_b32 s68, s38, s68
    s_cselect_b32 s69, 1024, s69
    s_add_u32 s31, s31, 32768
    s_add_u32 s28, s28, 32768
    s_and_b32 s31, s31, 131071
    s_mov_b32 m0, s31
    s_mov_b32 s54, s55
    v_exp_f32 v32, v32
    v_exp_f32 v33, v33
    v_smfmac_f32_16x16x64_bf16 v[104:107], v[80:83], v[56:63], v84
    v_exp_f32 v34, v34
    v_smfmac_f32_32x32x32_bf16 v[88:103], v[28:31], v[56:63], v84
    ds_read_b128 v[28:31], v5 offset:3072
    v_exp_f32 v35, v35
    v_exp_f32 v36, v36
    v_exp_f32 v37, v37
    v_mfma_f32_32x32x16_bf16 v[48:63], v[16:19], v[8:11], v[64:79]
    ds_read_b128 v[16:19], v5 offset:8192
    v_exp_f32 v38, v38
    v_exp_f32 v39, v39
    v_exp_f32 v40, v40
    v_mfma_f32_32x32x16_bf16 v[48:63], v[20:23], v[12:15], v[48:63]
    ds_read_b128 v[20:23], v5 offset:9216
    v_exp_f32 v41, v41
    v_exp_f32 v42, v42
    v_exp_f32 v43, v43
    s_waitcnt lgkmcnt(3)
    v_smfmac_f32_32x32x32_bf16 v[88:103], v[24:27], v[32:39], v84
    ds_read_b128 v[24:27], v5 offset:6144
    s_cmp_eq_u32 s54, 0
    s_cbranch_scc1 K2_burst0
K2_ret0:
    v_exp_f32 v44, v44
    v_exp_f32 v45, v45
    v_smfmac_f32_16x16x64_bf16 v[104:107], v[80:83], v[32:39], v84
    s_waitcnt lgkmcnt(1)
    v_exp_f32 v46, v46
    v_exp_f32 v47, v47
    v_exp_f32 v48, v48
    v_exp_f32 v49, v49
    v_smfmac_f32_16x16x64_bf16 v[104:107], v[80:83], v[40:47], v84
    v_exp_f32 v50, v50
    v_smfmac_f32_32x32x32_bf16 v[88:103], v[28:31], v[40:47], v84
    ds_read_b128 v[28:31], v5 offset:7168
    v_exp_f32 v51, v51
    v_exp_f32 v52, v52
    v_exp_f32 v53, v53
    v_mfma_f32_32x32x16_bf16 v[32:47], v[16:19], v[8:11], v[64:79]
    ds_read_b128 v[16:19], v5 offset:12288
    v_exp_f32 v54, v54
    v_exp_f32 v55, v55
    v_exp_f32 v56, v56
    v_mfma_f32_32x32x16_bf16 v[32:47], v[20:23], v[12:15], v[32:47]
    ds_read_b128 v[20:23], v5 offset:13312
    v_exp_f32 v57, v57
    v_exp_f32 v58, v58
    v_exp_f32 v59, v59
    s_waitcnt lgkmcnt(3)
    v_smfmac_f32_32x32x32_bf16 v[88:103], v[24:27], v[48:55], v84
    ds_read_b128 v[24:27], v5 offset:10240
    s_cmp_eq_u32 s54, 1
    s_cbranch_scc1 K2_burst1
K2_ret1:
    v_exp_f32 v60, v60
    v_exp_f32 v61, v61
    v_smfmac_f32_16x16x64_bf16 v[104:107], v[80:83], v[48:55], v84
    s_waitcnt lgkmcnt(1)
    v_exp_f32 v62, v62
    v_exp_f32 v63, v63
    v_exp_f32 v32, v32
    v_exp_f32 v33, v33
    v_smfmac_f32_16x16x64_bf16 v[104:107], v[80:83], v[56:63], v84
    v_exp_f32 v34, v34
    v_smfmac_f32_32x32x32_bf16 v[88:103], v[28:31], v[56:63], v84
    ds_read_b128 v[28:31], v5 offset:11264
    v_exp_f32 v35, v35
    v_exp_f32 v36, v36
    v_exp_f32 v37, v37
    v_mfma_f32_32x32x16_bf16 v[48:63], v[16:19], v[8:11], v[64:79]
    ds_read_b128 v[16:19], v5 offset:16384
    v_exp_f32 v38, v38
    v_exp_f32 v39, v39
    v_exp_f32 v40, v40
    v_mfma_f32_32x32x16_bf16 v[48:63], v[20:23], v[12:15], v[48:63]
    ds_read_b128 v[20:23], v5 offset:17408
    v_exp_f32 v41, v41
    v_exp_f32 v42, v42
    v_exp_f32 v43, v43
    s_waitcnt lgkmcnt(3)
    v_smfmac_f32_32x32x32_bf16 v[88:103], v[24:27], v[32:39], v84
    ds_read_b128 v[24:27], v5 offset:14336
    s_cmp_eq_u32 s54, 2
    s_cbranch_scc1 K2_burst2
K2_ret2:
    v_exp_f32 v44, v44
    v_exp_f32 v45, v45
    v_smfmac_f32_16x16x64_bf16 v[104:107], v[80:83], v[32:39], v84
    s_waitcnt lgkmcnt(1)
    v_exp_f32 v46, v46
    v_exp_f32 v47, v47
    v_exp_f32 v48, v48
    v_exp_f32 v49, v49
    v_smfmac_f32_16x16x64_bf16 v[104:107], v[80:83], v[40:47], v84
    v_exp_f32 v50, v50
    v_smfmac_f32_32x32x32_bf16 v[88:103], v[28:31], v[40:47], v84
    ds_read_b128 v[28:31], v5 offset:15360
    v_exp_f32 v51, v51
    v_exp_f32 v52, v52
    v_exp_f32 v53, v53
    v_mfma_f32_32x32x16_bf16 v[32:47], v[16:19], v[8:11], v[64:79]
    ds_read_b128 v[16:19], v5 offset:20480
    v_exp_f32 v54, v54
    v_exp_f32 v55, v55
    v_exp_f32 v56, v56
    v_mfma_f32_32x32x16_bf16 v[32:47], v[20:23], v[12:15], v[32:47]
    ds_read_b128 v[20:23], v5 offset:21504
    v_exp_f32 v57, v57
    v_exp_f32 v58, v58
    v_exp_f32 v59, v59
    s_waitcnt lgkmcnt(3)
    v_smfmac_f32_32x32x32_bf16 v[88:103], v[24:27], v[48:55], v84
    ds_read_b128 v[24:27], v5 offset:18432
    s_cmp_eq_u32 s54, 3
    s_cbranch_scc1 K2_burst3
K2_ret3:
    v_exp_f32 v60, v60
    v_exp_f32 v61, v61
    v_smfmac_f32_16x16x64_bf16 v[104:107], v[80:83], v[48:55], v84
    s_waitcnt lgkmcnt(1)
    v_exp_f32 v62, v62
    v_exp_f32 v63, v63
    s_setprio 2
    v_exp_f32 v32, v32
    v_exp_f32 v33, v33
    v_smfmac_f32_16x16x64_bf16 v[104:107], v[80:83], v[56:63], v84
    v_exp_f32 v34, v34
    v_smfmac_f32_32x32x32_bf16 v[88:103], v[28:31], v[56:63], v84
    ds_read_b128 v[28:31], v5 offset:19456
    v_exp_f32 v35, v35
    v_exp_f32 v36, v36
    v_exp_f32 v37, v37
    v_mfma_f32_32x32x16_bf16 v[48:63], v[16:19], v[8:11], v[64:79]
    ds_read_b128 v[16:19], v5 offset:24576
    v_exp_f32 v38, v38
    v_exp_f32 v39, v39
    v_exp_f32 v40, v40
    v_mfma_f32_32x32x16_bf16 v[48:63], v[20:23], v[12:15], v[48:63]
    ds_read_b128 v[20:23], v5 offset:25600
    v_exp_f32 v41, v41
    v_exp_f32 v42, v42
    v_exp_f32 v43, v43
    s_waitcnt lgkmcnt(3)
    v_smfmac_f32_32x32x32_bf16 v[88:103], v[24:27], v[32:39], v84
    ds_read_b128 v[24:27], v5 offset:22528
    s_cmp_eq_u32 s54, 4
    s_cbranch_scc1 K2_burst4
K2_ret4:
    v_exp_f32 v44, v44
    v_exp_f32 v45, v45
    v_smfmac_f32_16x16x64_bf16 v[104:107], v[80:83], v[32:39], v84
    s_waitcnt lgkmcnt(1)
    v_exp_f32 v46, v46
    v_exp_f32 v47, v47
    v_exp_f32 v48, v48
    v_exp_f32 v49, v49
    v_smfmac_f32_16x16x64_bf16 v[104:107], v[80:83], v[40:47], v84
    v_exp_f32 v50, v50
    v_smfmac_f32_32x32x32_bf16 v[88:103], v[28:31], v[40:47], v84
    ds_read_b128 v[28:31], v5 offset:23552
    v_exp_f32 v51, v51
    v_exp_f32 v52, v52
    v_exp_f32 v53, v53
    v_mfma_f32_32x32x16_bf16 v[32:47], v[16:19], v[8:11], v[64:79]
    ds_read_b128 v[16:19], v5 offset:28672
    v_exp_f32 v54, v54
    v_exp_f32 v55, v55
    v_exp_f32 v56, v56
    v_mfma_f32_32x32x16_bf16 v[32:47], v[20:23], v[12:15], v[32:47]
    ds_read_b128 v[20:23], v5 offset:29696
    v_exp_f32 v57, v57
    v_exp_f32 v58, v58
    v_exp_f32 v59, v59
    s_waitcnt lgkmcnt(3)
    v_smfmac_f32_32x32x32_bf16 v[88:103], v[24:27], v[48:55], v84
    ds_read_b128 v[24:27], v5 offset:26624
    s_cmp_eq_u32 s54, 5
    s_cbranch_scc1 K2_burst5
K2_ret5:
    v_exp_f32 v60, v60
    v_exp_f32 v61, v61
    v_smfmac_f32_16x16x64_bf16 v[104:107], v[80:83], v[48:55], v84
    s_waitcnt lgkmcnt(1)
    v_exp_f32 v62, v62
    v_exp_f32 v63, v63
    s_setprio 1
    v_exp_f32 v32, v32
    v_exp_f32 v33, v33
    v_smfmac_f32_16x16x64_bf16 v[104:107], v[80:83], v[56:63], v84
    v_exp_f32 v34, v34
    v_smfmac_f32_32x32x32_bf16 v[88:103], v[28:31], v[56:63], v84
    ds_read_b128 v[28:31], v5 offset:27648
    v_exp_f32 v35, v35
    v_exp_f32 v36, v36
    v_exp_f32 v37, v37
    v_mfma_f32_32x32x16_bf16 v[48:63], v[16:19], v[8:11], v[64:79]
    ds_read_b128 v[16:19], v4 offset:0
    v_exp_f32 v38, v38
    v_exp_f32 v39, v39
    v_exp_f32 v40, v40
    v_mfma_f32_32x32x16_bf16 v[48:63], v[20:23], v[12:15], v[48:63]
    ds_read_b128 v[20:23], v4 offset:1024
    v_exp_f32 v41, v41
    v_exp_f32 v42, v42
    v_exp_f32 v43, v43
    s_waitcnt lgkmcnt(3)
    v_smfmac_f32_32x32x32_bf16 v[88:103], v[24:27], v[32:39], v84
    ds_read_b128 v[24:27], v5 offset:30720
    s_cmp_eq_u32 s54, 6
    s_cbranch_scc1 K2_burst6
K2_ret6:
    v_exp_f32 v44, v44
    v_exp_f32 v45, v45
    v_smfmac_f32_16x16x64_bf16 v[104:107], v[80:83], v[32:39], v84
    s_waitcnt lgkmcnt(1)
    v_exp_f32 v46, v46
    v_exp_f32 v47, v47
    s_setprio 0
    v_exp_f32 v48, v48
    v_exp_f32 v49, v49
    v_smfmac_f32_16x16x64_bf16 v[104:107], v[80:83], v[40:47], v84
    v_exp_f32 v50, v50
    v_smfmac_f32_32x32x32_bf16 v[88:103], v[28:31], v[40:47], v84
    ds_read_b128 v[28:31], v5 offset:31744
    v_exp_f32 v51, v51
    v_exp_f32 v52, v52
    v_exp_f32 v53, v53
    v_mfma_f32_32x32x16_bf16 v[32:47], v[16:19], v[8:11], v[64:79]
    ds_read_b128 v[16:19], v4 offset:4096
    v_exp_f32 v54, v54
    v_exp_f32 v55, v55
    v_exp_f32 v56, v56
    v_mfma_f32_32x32x16_bf16 v[32:47], v[20:23], v[12:15], v[32:47]
    ds_read_b128 v[20:23], v4 offset:5120
    v_exp_f32 v57, v57
    v_exp_f32 v58, v58
    v_exp_f32 v59, v59
    s_waitcnt lgkmcnt(3)
    v_smfmac_f32_32x32x32_bf16 v[88:103], v[24:27], v[48:55], v84
    ds_read_b128 v[24:27], v4 offset:2048
    s_cmp_eq_u32 s54, 7
    s_cbranch_scc1 K2_burst7
K2_ret7:
    v_exp_f32 v60, v60
    v_exp_f32 v61, v61
    v_smfmac_f32_16x16x64_bf16 v[104:107], v[80:83], v[48:55], v84
    s_waitcnt lgkmcnt(1)
    v_exp_f32 v62, v62
    v_exp_f32 v63, v63
    v_mov_b32 v5, v4
    v_add_u32 v4, 32768, v4
    v_and_b32 v4, 131071, v4
    s_add_u32 s32, s32, 1
    s_cmp_lt_u32 s32, 8
    s_cbranch_scc1 K2_chunk
    v_smfmac_f32_16x16x64_bf16 v[104:107], v[80:83], v[56:63], v84
    v_smfmac_f32_32x32x32_bf16 v[88:103], v[28:31], v[56:63], v84
    v_mov_b32 v3, 0x5d800000
    s_nop 5
    v_cmp_nlt_f32 vcc, v104, v3
    v_rcp_f32 v208, v104
    s_nop 3
    s_cmp_eq_u64 vcc, 0
    s_cbranch_scc0 K2_fallback
K2_fin:
    v_pk_mul_f32 v[88:89], v[88:89], v[208:209] op_sel_hi:[1,0]
    v_pk_mul_f32 v[90:91], v[90:91], v[208:209] op_sel_hi:[1,0]
    v_pk_mul_f32 v[92:93], v[92:93], v[208:209] op_sel_hi:[1,0]
    v_pk_mul_f32 v[94:95], v[94:95], v[208:209] op_sel_hi:[1,0]
    v_cvt_pk_bf16_f32 v88, v88, v89
    v_cvt_pk_bf16_f32 v89, v90, v91
    v_cvt_pk_bf16_f32 v90, v92, v93
    v_cvt_pk_bf16_f32 v91, v94, v95
    buffer_store_dwordx4 v[88:91], v1, s[24:27], s41 offen offset:0 sc1
    v_pk_mul_f32 v[96:97], v[96:97], v[208:209] op_sel_hi:[1,0]
    v_pk_mul_f32 v[98:99], v[98:99], v[208:209] op_sel_hi:[1,0]
    v_pk_mul_f32 v[100:101], v[100:101], v[208:209] op_sel_hi:[1,0]
    v_pk_mul_f32 v[102:103], v[102:103], v[208:209] op_sel_hi:[1,0]
    v_cvt_pk_bf16_f32 v92, v96, v97
    v_cvt_pk_bf16_f32 v93, v98, v99
    v_cvt_pk_bf16_f32 v94, v100, v101
    v_cvt_pk_bf16_f32 v95, v102, v103
    buffer_store_dwordx4 v[92:95], v1, s[24:27], s41 offen offset:1024 sc1
    s_setprio 0
    s_mov_b32 s57, s35
    s_and_b32 s3, s2, 7
    s_lshr_b32 s36, s2, 3
    s_lshr_b32 s42, s3, 2
    s_and_b32 s35, s3, 1
    s_lshl_b32 s35, s35, 3
    s_and_b32 s37, s36, 3
    s_lshl_b32 s37, s37, 1
    s_add_u32 s35, s35, s37
    s_lshl_b32 s56, s35, 7
    s_add_u32 s56, s56, 27262976
    s_bfe_u32 s37, s36, 0x10002
    s_add_u32 s35, s35, s37
    s_bfe_u32 s40, s3, 0x10001
    s_lshl_b32 s40, s40, 2
    s_lshr_b32 s37, s36, 3
    s_add_u32 s40, s40, s37
    v_lshlrev_b32 v1, 4, v0
    s_lshl_b32 s28, s42, 22
    s_lshl_b32 s3, s35, 18
    s_add_u32 s28, s28, s3
    s_lshr_b32 s3, s34, 1
    s_lshl_b32 s3, s3, 16
    s_add_u32 s28, s28, s3
    s_and_b32 s39, s34, 1
    s_lshl_b32 s3, s39, 11
    s_add_u32 s28, s28, s3
    s_add_u32 s28, s28, 18874368
    v_bfe_u32 v12, v0, 2, 2
    v_and_b32 v14, 3, v0
    v_lshrrev_b32 v2, 4, v0
    v_lshlrev_b32 v2, 6, v2
    v_lshl_add_u32 v2, v12, 11, v2
    v_lshl_add_u32 v2, v14, 4, v2
    v_add_u32 v3, 7168, v2
    s_lshl_b32 s29, s34, 14
    s_lshl_b32 s3, s40, 8
    s_add_u32 s29, s29, s3
    s_lshl_b32 s31, s34, 12
    s_add_u32 s41, s31, 163840
    s_cmp_eq_u32 s42, 0
    s_cselect_b32 s44, s88, s92
    s_cselect_b32 s45, s89, s93
    s_mov_b64 s[50:51], s[94:95]
    s_sub_u32 s12, s44, 2048
    s_subb_u32 s13, s45, 0
    s_and_b32 s13, s13, 0xffff
    s_mov_b32 s14, 2099200
    s_mov_b32 s15, 0x00020000
    s_waitcnt vmcnt(0)
    s_barrier
    s_cmp_lg_u32 s34, 0
    s_cbranch_scc1 K3_noflag
    s_lshl_b32 s3, s57, 2
    s_add_u32 s3, s3, s56
    v_mov_b32 v4, 0
    v_mov_b32 v5, 1
    s_mov_b64 exec, 1
    buffer_store_dword v5, v4, s[24:27], s3 offen sc1
    s_mov_b64 exec, -1
K3_noflag:
    s_add_u32 m0, s31, 0
    s_nop 0
    buffer_load_dwordx4 v2, s[12:15], s29 offen offset:2048 lds
    buffer_load_dwordx4 v3, s[12:15], s29 offen offset:3072 lds
    s_add_u32 s29, s29, 131072
    s_add_u32 m0, s31, 32768
    s_nop 0
    buffer_load_dwordx4 v2, s[12:15], s29 offen offset:2048 lds
    buffer_load_dwordx4 v3, s[12:15], s29 offen offset:3072 lds
    s_add_u32 s29, s29, 131072
    s_add_u32 m0, s31, 65536
    s_nop 0
    buffer_load_dwordx4 v2, s[12:15], s29 offen offset:2048 lds
    buffer_load_dwordx4 v3, s[12:15], s29 offen offset:3072 lds
    s_add_u32 s29, s29, 131072
    s_add_u32 m0, s31, 98304
    s_nop 0
    buffer_load_dwordx4 v2, s[12:15], s29 offen offset:2048 lds
    buffer_load_dwordx4 v3, s[12:15], s29 offen offset:3072 lds
    s_add_u32 s29, s29, 131072
    s_lshr_b32 s43, s34, 2
    s_bfe_u32 s38, s34, 0x10001
    v_lshrrev_b32 v13, 5, v0
    s_lshl_b32 s3, s38, 2
    s_add_u32 s3, s3, s43
    s_lshl_b32 s3, s3, 12
    v_add_u32 v5, s3, v1
    v_mov_b32 v6, v5
    v_lshlrev_b32 v7, 10, v13
    v_lshl_add_u32 v7, v12, 6, v7
    v_bfe_u32 v11, v0, 4, 1
    v_lshl_add_u32 v7, v11, 5, v7
    v_lshl_add_u32 v7, v14, 3, v7
    s_lshl_b32 s3, s43, 14
    s_lshl_b32 s37, s39, 9
    s_add_u32 s3, s3, s37
    s_add_u32 s3, s3, 2048
    v_add_u32 v7, s3, v7
    v_mov_b32 v8, v7
    s_mov_b32 s32, 0
    s_mov_b32 s46, 0
    s_mov_b32 s64, 4294836224
    v_mov_b32 v16, 0
    v_mov_b32 v17, 0
    v_mov_b32 v18, 0
    v_mov_b32 v19, 0
    v_mov_b32 v20, 0
    v_mov_b32 v21, 0
    v_mov_b32 v22, 0
    v_mov_b32 v23, 0
    v_mov_b32 v24, 0
    v_mov_b32 v25, 0
    v_mov_b32 v26, 0
    v_mov_b32 v27, 0
    v_mov_b32 v28, 0
    v_mov_b32 v29, 0
    v_mov_b32 v30, 0
    v_mov_b32 v31, 0
    v_mov_b32 v32, 0
    v_mov_b32 v33, 0
    v_mov_b32 v34, 0
    v_mov_b32 v35, 0
    v_mov_b32 v36, 0
    v_mov_b32 v37, 0
    v_mov_b32 v38, 0
    v_mov_b32 v39, 0
    v_mov_b32 v40, 0
    v_mov_b32 v41, 0
    v_mov_b32 v42, 0
    v_mov_b32 v43, 0
    v_mov_b32 v44, 0
    v_mov_b32 v45, 0
    v_mov_b32 v46, 0
    v_mov_b32 v47, 0
    v_mov_b32 v48, 0
    v_mov_b32 v49, 0
    v_mov_b32 v50, 0
    v_mov_b32 v51, 0
    v_mov_b32 v52, 0
    v_mov_b32 v53, 0
    v_mov_b32 v54, 0
    v_mov_b32 v55, 0
    v_mov_b32 v56, 0
    v_mov_b32 v57, 0
    v_mov_b32 v58, 0
    v_mov_b32 v59, 0
    v_mov_b32 v60, 0
    v_mov_b32 v61, 0
    v_mov_b32 v62, 0
    v_mov_b32 v63, 0
    v_mov_b32 v64, 0
    v_mov_b32 v65, 0
    v_mov_b32 v66, 0
    v_mov_b32 v67, 0
    v_mov_b32 v68, 0
    v_mov_b32 v69, 0
    v_mov_b32 v70, 0
    v_mov_b32 v71, 0
    v_mov_b32 v72, 0
    v_mov_b32 v73, 0
    v_mov_b32 v74, 0
    v_mov_b32 v75, 0
    v_mov_b32 v76, 0
    v_mov_b32 v77, 0
    v_mov_b32 v78, 0
    v_mov_b32 v79, 0
    s_mov_b32 s16, s50
    s_and_b32 s17, s51, 0xffff
    s_mov_b32 s18, 8388608
    s_mov_b32 s19, 0x00020000
    s_lshl_b32 s47, s35, 19
    s_lshl_b32 s3, s38, 18
    s_add_u32 s47, s47, s3
    s_lshl_b32 s3, s43, 17
    s_add_u32 s47, s47, s3
    s_lshl_b32 s3, s42, 11
    s_add_u32 s47, s47, s3
    s_lshl_b32 s3, s40, 8
    s_add_u32 s47, s47, s3
    s_lshl_b32 s3, s39, 7
    s_add_u32 s47, s47, s3
    s_cmp_lg_u32 s34, 0
    s_cbranch_scc1 K3_polled
    v_and_b32 v4, 31, v0
    v_lshlrev_b32 v4, 2, v4
    s_mov_b32 s3, 524288
K3_poll:
    buffer_load_dword v9, v4, s[24:27], s56 offen sc1
    s_sub_u32 s3, s3, 1
    s_cbranch_scc1 K3_polled
    s_waitcnt vmcnt(0)
    v_cmp_ne_u32 vcc, 1, v9
    s_nop 3
    s_cmp_eq_u64 vcc, 0
    s_cbranch_scc0 K3_poll
K3_polled:
    s_barrier
    s_mov_b32 m0, s31
    s_add_u32 s31, s31, 32768
    buffer_load_dwordx4 v1, s[24:27], s28 offen sc1 lds
    buffer_load_dwordx4 v1, s[24:27], s28 offen offset:1024 sc1 lds
    s_add_u32 s28, s28, 4096
    s_mov_b32 m0, s31
    s_add_u32 s31, s31, 32768
    buffer_load_dwordx4 v1, s[24:27], s28 offen sc1 lds
    buffer_load_dwordx4 v1, s[24:27], s28 offen offset:1024 sc1 lds
    s_add_u32 s28, s28, 4096
    s_mov_b32 m0, s31
    s_add_u32 s31, s31, 32768
    buffer_load_dwordx4 v1, s[24:27], s28 offen sc1 lds
    buffer_load_dwordx4 v1, s[24:27], s28 offen offset:1024 sc1 lds
    s_add_u32 s28, s28, 4096
    s_mov_b32 m0, s31
    s_add_u32 s31, s31, 32768
    buffer_load_dwordx4 v1, s[24:27], s28 offen sc1 lds
    buffer_load_dwordx4 v1, s[24:27], s28 offen offset:1024 sc1 lds
    s_add_u32 s28, s28, 4096
    s_waitcnt vmcnt(6)
    s_barrier
    ds_read_b128 v[80:83], v5 offset:0
    ds_read_b64_tr_b16 v[88:89], v7 offset:0
    ds_read_b64_tr_b16 v[90:91], v7 offset:4096
    ds_read_b64_tr_b16 v[92:93], v7 offset:256
    ds_read_b64_tr_b16 v[94:95], v7 offset:4352
    ds_read_b128 v[84:87], v5 offset:8192
.p2align 6
K3_loop:
    s_waitcnt lgkmcnt(0)
    v_mfma_f32_32x32x16_bf16 v[16:31], v[88:91], v[80:83], v[16:31]
    ds_read_b128 v[96:99], v6 offset:1024
    ds_read_b64_tr_b16 v[104:105], v8 offset:8192
    v_mfma_f32_32x32x16_bf16 v[32:47], v[92:95], v[80:83], v[32:47]
    ds_read_b64_tr_b16 v[106:107], v8 offset:12288
    ds_read_b64_tr_b16 v[108:109], v8 offset:8448
    v_mfma_f32_32x32x16_bf16 v[48:63], v[88:91], v[84:87], v[48:63]
    ds_read_b64_tr_b16 v[110:111], v8 offset:12544
    ds_read_b128 v[100:103], v6 offset:9216
    s_sub_u32 s3, s32, 2
    s_cmp_ge_u32 s3, 11
    v_mfma_f32_32x32x16_bf16 v[64:79], v[92:95], v[84:87], v[64:79]
    s_cbranch_scc1 K3_loop_tw
    s_waitcnt vmcnt(8)
K3_loop_back:
    s_barrier
    s_add_u32 s46, s46, 1
    s_cmp_eq_u32 s46, 5
    s_cselect_b32 s33, s64, 32768
    s_cselect_b32 s46, 0, s46
    s_waitcnt lgkmcnt(0)
    v_mfma_f32_32x32x16_bf16 v[16:31], v[104:107], v[96:99], v[16:31]
    v_add_u32 v5, s33, v5
    v_add_u32 v7, s33, v7
    ds_read_b128 v[80:83], v5 offset:0
    ds_read_b64_tr_b16 v[88:89], v7 offset:0
    v_mfma_f32_32x32x16_bf16 v[32:47], v[108:111], v[96:99], v[32:47]
    ds_read_b64_tr_b16 v[90:91], v7 offset:4096
    ds_read_b64_tr_b16 v[92:93], v7 offset:256
    ds_read_b64_tr_b16 v[94:95], v7 offset:4352
    ds_read_b128 v[84:87], v5 offset:8192
    s_cmp_ge_u32 s32, 12
    v_mfma_f32_32x32x16_bf16 v[48:63], v[104:107], v[100:103], v[48:63]
    v_add_u32 v6, s33, v6
    v_add_u32 v8, s33, v8
    s_cbranch_scc1 K3_loop_nodma
    s_mov_b32 m0, s31
    s_add_u32 s31, s31, 32768
    buffer_load_dwordx4 v1, s[24:27], s28 offen sc1 lds
    buffer_load_dwordx4 v2, s[12:15], s29 offen offset:2048 lds
    buffer_load_dwordx4 v1, s[24:27], s28 offen offset:1024 sc1 lds
    buffer_load_dwordx4 v3, s[12:15], s29 offen offset:3072 lds
    s_add_u32 s28, s28, 4096
    s_add_u32 s29, s29, 131072
    s_cmp_ge_u32 s31, s41
    s_cselect_b32 s3, 163840, 0
    s_sub_u32 s31, s31, s3
K3_loop_nodma:
    s_add_u32 s32, s32, 1
    s_cmp_lt_u32 s32, 16
    v_mfma_f32_32x32x16_bf16 v[64:79], v[108:111], v[100:103], v[64:79]
    s_cbranch_scc1 K3_loop
    s_branch K3_loop_done
K3_loop_tw:
    s_cmp_ge_u32 s32, 2
    s_cbranch_scc1 K3_loop_twl
    s_waitcnt vmcnt(6)
    s_cmp_eq_u32 s32, 1
    s_cbranch_scc1 K3_loop_back
    s_waitcnt vmcnt(4)
    s_branch K3_loop_back
K3_loop_twl:
    s_cmp_eq_u32 s32, 13
    s_cbranch_scc1 K3_loop_tw1
    s_waitcnt vmcnt(0)
    s_branch K3_loop_back
K3_loop_tw1:
    s_waitcnt vmcnt(4)
    s_branch K3_loop_back
K3_loop_done:
    s_and_b32 s3, s34, 3
    s_lshl_b32 s3, s3, 14
    s_add_u32 s3, s3, 65536
    v_add_u32 v2, s3, v1
    v_and_b32 v112, 7, v0
    v_xor_b32 v113, v13, v112
    v_and_b32 v3, 31, v0
    v_lshlrev_b32 v3, 7, v3
    v_lshl_add_u32 v113, v113, 4, v3
    v_add_u32 v113, s3, v113
    v_xor_b32 v114, 32, v113
    v_xor_b32 v115, 64, v113
    v_xor_b32 v116, 0x60, v113
    v_lshrrev_b32 v3, 3, v0
    v_xor_b32 v117, v3, v112
    v_lshlrev_b32 v117, 4, v117
    v_lshl_add_u32 v117, v3, 7, v117
    v_add_u32 v117, s3, v117
    v_lshlrev_b32 v3, 12, v3
    v_lshl_add_u32 v3, v112, 4, v3
    s_cmp_eq_u32 s43, 0
    s_nop 15
    s_waitcnt lgkmcnt(0)
    s_cbranch_scc0 K3_g1
    ds_write_b128 v2, v[48:51] offset:8192
    ds_write_b128 v2, v[52:55] offset:9216
    ds_write_b128 v2, v[56:59] offset:10240
    ds_write_b128 v2, v[60:63] offset:11264
    ds_write_b128 v2, v[64:67] offset:12288
    ds_write_b128 v2, v[68:71] offset:13312
    ds_write_b128 v2, v[72:75] offset:14336
    ds_write_b128 v2, v[76:79] offset:15360
    s_waitcnt lgkmcnt(0)
    s_barrier
    ds_read_b128 v[80:83], v2 offset:0
    ds_read_b128 v[84:87], v2 offset:1024
    ds_read_b128 v[88:91], v2 offset:2048
    ds_read_b128 v[92:95], v2 offset:3072
    ds_read_b128 v[96:99], v2 offset:4096
    ds_read_b128 v[100:103], v2 offset:5120
    ds_read_b128 v[104:107], v2 offset:6144
    ds_read_b128 v[108:111], v2 offset:7168
    s_waitcnt lgkmcnt(6)
    v_pk_add_f32 v[16:17], v[16:17], v[80:81]
    v_pk_add_f32 v[18:19], v[18:19], v[82:83]
    v_pk_add_f32 v[20:21], v[20:21], v[84:85]
    v_pk_add_f32 v[22:23], v[22:23], v[86:87]
    v_cvt_pk_bf16_f32 v16, v16, v17
    v_cvt_pk_bf16_f32 v17, v18, v19
    v_cvt_pk_bf16_f32 v18, v20, v21
    v_cvt_pk_bf16_f32 v19, v22, v23
    s_nop 0
    v_permlane32_swap_b32 v16, v18
    v_permlane32_swap_b32 v17, v19
    ds_write_b128 v113, v[16:19] offset:0
    s_waitcnt lgkmcnt(5)
    v_pk_add_f32 v[24:25], v[24:25], v[88:89]
    v_pk_add_f32 v[26:27], v[26:27], v[90:91]
    v_pk_add_f32 v[28:29], v[28:29], v[92:93]
    v_pk_add_f32 v[30:31], v[30:31], v[94:95]
    v_cvt_pk_bf16_f32 v20, v24, v25
    v_cvt_pk_bf16_f32 v21, v26, v27
    v_cvt_pk_bf16_f32 v22, v28, v29
    v_cvt_pk_bf16_f32 v23, v30, v31
    s_nop 0
    v_permlane32_swap_b32 v20, v22
    v_permlane32_swap_b32 v21, v23
    ds_write_b128 v114, v[20:23] offset:0
    s_waitcnt lgkmcnt(4)
    v_pk_add_f32 v[32:33], v[32:33], v[96:97]
    v_pk_add_f32 v[34:35], v[34:35], v[98:99]
    v_pk_add_f32 v[36:37], v[36:37], v[100:101]
    v_pk_add_f32 v[38:39], v[38:39], v[102:103]
    v_cvt_pk_bf16_f32 v32, v32, v33
    v_cvt_pk_bf16_f32 v33, v34, v35
    v_cvt_pk_bf16_f32 v34, v36, v37
    v_cvt_pk_bf16_f32 v35, v38, v39
    s_nop 0
    v_permlane32_swap_b32 v32, v34
    v_permlane32_swap_b32 v33, v35
    ds_write_b128 v115, v[32:35] offset:0
    s_waitcnt lgkmcnt(3)
    v_pk_add_f32 v[40:41], v[40:41], v[104:105]
    v_pk_add_f32 v[42:43], v[42:43], v[106:107]
    v_pk_add_f32 v[44:45], v[44:45], v[108:109]
    v_pk_add_f32 v[46:47], v[46:47], v[110:111]
    v_cvt_pk_bf16_f32 v36, v40, v41
    v_cvt_pk_bf16_f32 v37, v42, v43
    v_cvt_pk_bf16_f32 v38, v44, v45
    v_cvt_pk_bf16_f32 v39, v46, v47
    s_nop 0
    v_permlane32_swap_b32 v36, v38
    v_permlane32_swap_b32 v37, v39
    ds_write_b128 v116, v[36:39] offset:0
    ds_read_b128 v[80:83], v117 offset:0
    ds_read_b128 v[84:87], v117 offset:1024
    ds_read_b128 v[88:91], v117 offset:2048
    ds_read_b128 v[92:95], v117 offset:3072
    s_waitcnt lgkmcnt(3)
    buffer_store_dwordx4 v[80:83], v3, s[16:19], s47 offen sc1
    s_add_u32 s47, s47, 0x8000
    s_waitcnt lgkmcnt(2)
    buffer_store_dwordx4 v[84:87], v3, s[16:19], s47 offen sc1
    s_add_u32 s47, s47, 0x8000
    s_waitcnt lgkmcnt(1)
    buffer_store_dwordx4 v[88:91], v3, s[16:19], s47 offen sc1
    s_add_u32 s47, s47, 0x8000
    s_waitcnt lgkmcnt(0)
    buffer_store_dwordx4 v[92:95], v3, s[16:19], s47 offen sc1
    s_endpgm
K3_g1:
    ds_write_b128 v2, v[16:19] offset:0
    ds_write_b128 v2, v[20:23] offset:1024
    ds_write_b128 v2, v[24:27] offset:2048
    ds_write_b128 v2, v[28:31] offset:3072
    ds_write_b128 v2, v[32:35] offset:4096
    ds_write_b128 v2, v[36:39] offset:5120
    ds_write_b128 v2, v[40:43] offset:6144
    ds_write_b128 v2, v[44:47] offset:7168
    s_waitcnt lgkmcnt(0)
    s_barrier
    ds_read_b128 v[80:83], v2 offset:8192
    ds_read_b128 v[84:87], v2 offset:9216
    ds_read_b128 v[88:91], v2 offset:10240
    ds_read_b128 v[92:95], v2 offset:11264
    ds_read_b128 v[96:99], v2 offset:12288
    ds_read_b128 v[100:103], v2 offset:13312
    ds_read_b128 v[104:107], v2 offset:14336
    ds_read_b128 v[108:111], v2 offset:15360
    s_waitcnt lgkmcnt(6)
    v_pk_add_f32 v[48:49], v[48:49], v[80:81]
    v_pk_add_f32 v[50:51], v[50:51], v[82:83]
    v_pk_add_f32 v[52:53], v[52:53], v[84:85]
    v_pk_add_f32 v[54:55], v[54:55], v[86:87]
    v_cvt_pk_bf16_f32 v48, v48, v49
    v_cvt_pk_bf16_f32 v49, v50, v51
    v_cvt_pk_bf16_f32 v50, v52, v53
    v_cvt_pk_bf16_f32 v51, v54, v55
    s_nop 0
    v_permlane32_swap_b32 v48, v50
    v_permlane32_swap_b32 v49, v51
    ds_write_b128 v113, v[48:51] offset:8192
    s_waitcnt lgkmcnt(5)
    v_pk_add_f32 v[56:57], v[56:57], v[88:89]
    v_pk_add_f32 v[58:59], v[58:59], v[90:91]
    v_pk_add_f32 v[60:61], v[60:61], v[92:93]
    v_pk_add_f32 v[62:63], v[62:63], v[94:95]
    v_cvt_pk_bf16_f32 v52, v56, v57
    v_cvt_pk_bf16_f32 v53, v58, v59
    v_cvt_pk_bf16_f32 v54, v60, v61
    v_cvt_pk_bf16_f32 v55, v62, v63
    s_nop 0
    v_permlane32_swap_b32 v52, v54
    v_permlane32_swap_b32 v53, v55
    ds_write_b128 v114, v[52:55] offset:8192
    s_waitcnt lgkmcnt(4)
    v_pk_add_f32 v[64:65], v[64:65], v[96:97]
    v_pk_add_f32 v[66:67], v[66:67], v[98:99]
    v_pk_add_f32 v[68:69], v[68:69], v[100:101]
    v_pk_add_f32 v[70:71], v[70:71], v[102:103]
    v_cvt_pk_bf16_f32 v64, v64, v65
    v_cvt_pk_bf16_f32 v65, v66, v67
    v_cvt_pk_bf16_f32 v66, v68, v69
    v_cvt_pk_bf16_f32 v67, v70, v71
    s_nop 0
    v_permlane32_swap_b32 v64, v66
    v_permlane32_swap_b32 v65, v67
    ds_write_b128 v115, v[64:67] offset:8192
    s_waitcnt lgkmcnt(3)
    v_pk_add_f32 v[72:73], v[72:73], v[104:105]
    v_pk_add_f32 v[74:75], v[74:75], v[106:107]
    v_pk_add_f32 v[76:77], v[76:77], v[108:109]
    v_pk_add_f32 v[78:79], v[78:79], v[110:111]
    v_cvt_pk_bf16_f32 v68, v72, v73
    v_cvt_pk_bf16_f32 v69, v74, v75
    v_cvt_pk_bf16_f32 v70, v76, v77
    v_cvt_pk_bf16_f32 v71, v78, v79
    s_nop 0
    v_permlane32_swap_b32 v68, v70
    v_permlane32_swap_b32 v69, v71
    ds_write_b128 v116, v[68:71] offset:8192
    ds_read_b128 v[80:83], v117 offset:8192
    ds_read_b128 v[84:87], v117 offset:9216
    ds_read_b128 v[88:91], v117 offset:10240
    ds_read_b128 v[92:95], v117 offset:11264
    s_waitcnt lgkmcnt(3)
    buffer_store_dwordx4 v[80:83], v3, s[16:19], s47 offen sc1
    s_add_u32 s47, s47, 0x8000
    s_waitcnt lgkmcnt(2)
    buffer_store_dwordx4 v[84:87], v3, s[16:19], s47 offen sc1
    s_add_u32 s47, s47, 0x8000
    s_waitcnt lgkmcnt(1)
    buffer_store_dwordx4 v[88:91], v3, s[16:19], s47 offen sc1
    s_add_u32 s47, s47, 0x8000
    s_waitcnt lgkmcnt(0)
    buffer_store_dwordx4 v[92:95], v3, s[16:19], s47 offen sc1
    s_endpgm
K2_wA:
    s_cmp_eq_u32 s32, 7
    s_cbranch_scc1 K2_go
    s_waitcnt vmcnt(5)
    s_cmp_eq_u32 s32, 0
    s_cbranch_scc1 K2_bar
    s_waitcnt vmcnt(0)
    s_branch K2_bar
K2_burst0:
    s_cmp_ge_u32 s32, 5
    s_cbranch_scc1 K2_late0
    buffer_load_dwordx4 v1, s[24:27], s28 offen offset:0 lds
    buffer_load_dwordx4 v1, s[24:27], s28 offen offset:1024 lds
    buffer_load_dwordx4 v1, s[24:27], s28 offen offset:2048 lds
    buffer_load_dwordx4 v1, s[24:27], s28 offen offset:3072 lds
    s_add_u32 s54, s54, 4
    s_branch K2_ret0
K2_late0:
    s_cmp_eq_u32 s32, 6
    s_cbranch_scc1 K2_blkZ0
    s_cmp_eq_u32 s32, 7
    s_cbranch_scc1 K2_blkF0
    v_add_u32 v3, 131072, v1
    ds_read_b128 v[136:139], v3 offset:0
    ds_read_b128 v[140:143], v3 offset:1024
    ds_read_b128 v[144:147], v3 offset:2048
    ds_read_b128 v[148:151], v3 offset:3072
    v_add_u32 v3, 135168, v2
    ds_read_b32 v152, v3 offset:0
    ds_read_b32 v153, v3 offset:256
    ds_read_b32 v154, v3 offset:512
    ds_read_b32 v155, v3 offset:768
    ds_read_b32 v156, v3 offset:1024
    ds_read_b32 v157, v3 offset:1280
    ds_read_b32 v158, v3 offset:1536
    ds_read_b32 v159, v3 offset:1792
    s_add_u32 s54, s54, 4
    v_lshlrev_b32 v3, 5, v0
    buffer_load_dword v207, v3, s[48:51], s52 offen
    s_branch K2_ret0
K2_blkZ0:
    v_cvt_pk_bf16_f32 v152, v152, v153
    v_cvt_pk_bf16_f32 v153, v154, v155
    v_cvt_pk_bf16_f32 v154, v156, v157
    v_cvt_pk_bf16_f32 v155, v158, v159
    v_mfma_f32_32x32x16_bf16 v[184:199], v[144:147], v[120:123], 0
    v_cvt_pk_bf16_f32 v156, v160, v161
    v_cvt_pk_bf16_f32 v157, v162, v163
    v_cvt_pk_bf16_f32 v158, v164, v165
    v_cvt_pk_bf16_f32 v159, v166, v167
    v_cvt_pk_bf16_f32 v160, v168, v169
    v_cvt_pk_bf16_f32 v161, v170, v171
    v_cvt_pk_bf16_f32 v162, v172, v173
    v_cvt_pk_bf16_f32 v163, v174, v175
    v_mfma_f32_32x32x16_bf16 v[184:199], v[148:151], v[124:127], v[184:199]
    v_cvt_pk_bf16_f32 v164, v176, v177
    v_cvt_pk_bf16_f32 v165, v178, v179
    v_cvt_pk_bf16_f32 v166, v180, v181
    v_cvt_pk_bf16_f32 v167, v182, v183
    v_mfma_f32_32x32x16_bf16 v[168:183], v[136:139], v[112:115], 0
    v_cndmask_b32 v152, v108, v152, s[66:67]
    v_cndmask_b32 v153, v108, v153, s[66:67]
    v_cndmask_b32 v154, v108, v154, s[66:67]
    v_cndmask_b32 v155, v108, v155, s[66:67]
    v_cndmask_b32 v160, v108, v160, s[66:67]
    v_cndmask_b32 v161, v108, v161, s[66:67]
    v_cndmask_b32 v162, v108, v162, s[66:67]
    v_cndmask_b32 v163, v108, v163, s[66:67]
    v_mfma_f32_32x32x16_bf16 v[168:183], v[140:143], v[116:119], v[168:183]
    v_cndmask_b32 v156, v108, v156, s[66:67]
    v_cndmask_b32 v157, v108, v157, s[66:67]
    v_cndmask_b32 v158, v108, v158, s[66:67]
    v_cndmask_b32 v159, v108, v159, s[66:67]
    v_cndmask_b32 v164, v108, v164, s[66:67]
    v_cndmask_b32 v165, v108, v165, s[66:67]
    v_cndmask_b32 v166, v108, v166, s[66:67]
    v_cndmask_b32 v167, v108, v167, s[66:67]
    v_mfma_f32_16x16x32_bf16 v[200:203], v[152:155], v[112:115], 0
    v_mfma_f32_16x16x32_bf16 v[204:207], v[160:163], v[120:123], 0
    v_mfma_f32_16x16x32_bf16 v[200:203], v[156:159], v[116:119], v[200:203]
    v_mfma_f32_16x16x32_bf16 v[204:207], v[164:167], v[124:127], v[204:207]
    s_branch K2_ret0
K2_blkF0:
    v_rcp_f32 v200, v200
    v_rcp_f32 v204, v204
    v_mov_b32 v208, 0x358637bd
    v_fmac_f32 v208, v200, v201
    v_fmac_f32 v208, v204, v205
    v_rcp_f32 v208, v208
    s_nop 0
    v_mul_f32 v200, v200, v208
    v_mul_f32 v204, v204, v208
    v_pk_mul_f32 v[168:169], v[168:169], v[200:201] op_sel_hi:[1,0]
    v_pk_mul_f32 v[170:171], v[170:171], v[200:201] op_sel_hi:[1,0]
    v_pk_mul_f32 v[172:173], v[172:173], v[200:201] op_sel_hi:[1,0]
    v_pk_mul_f32 v[174:175], v[174:175], v[200:201] op_sel_hi:[1,0]
    v_pk_fma_f32 v[168:169], v[184:185], v[204:205], v[168:169] op_sel_hi:[1,0,1]
    v_pk_fma_f32 v[170:171], v[186:187], v[204:205], v[170:171] op_sel_hi:[1,0,1]
    v_pk_fma_f32 v[172:173], v[188:189], v[204:205], v[172:173] op_sel_hi:[1,0,1]
    v_pk_fma_f32 v[174:175], v[190:191], v[204:205], v[174:175] op_sel_hi:[1,0,1]
    v_cvt_pk_bf16_f32 v168, v168, v169
    v_cvt_pk_bf16_f32 v169, v170, v171
    v_cvt_pk_bf16_f32 v170, v172, v173
    v_cvt_pk_bf16_f32 v171, v174, v175
    buffer_store_dwordx4 v[168:171], v1, s[24:27], s40 offen offset:0 sc1
    v_pk_mul_f32 v[176:177], v[176:177], v[200:201] op_sel_hi:[1,0]
    v_pk_mul_f32 v[178:179], v[178:179], v[200:201] op_sel_hi:[1,0]
    v_pk_mul_f32 v[180:181], v[180:181], v[200:201] op_sel_hi:[1,0]
    v_pk_mul_f32 v[182:183], v[182:183], v[200:201] op_sel_hi:[1,0]
    v_pk_fma_f32 v[176:177], v[192:193], v[204:205], v[176:177] op_sel_hi:[1,0,1]
    v_pk_fma_f32 v[178:179], v[194:195], v[204:205], v[178:179] op_sel_hi:[1,0,1]
    v_pk_fma_f32 v[180:181], v[196:197], v[204:205], v[180:181] op_sel_hi:[1,0,1]
    v_pk_fma_f32 v[182:183], v[198:199], v[204:205], v[182:183] op_sel_hi:[1,0,1]
    v_cvt_pk_bf16_f32 v172, v176, v177
    v_cvt_pk_bf16_f32 v173, v178, v179
    v_cvt_pk_bf16_f32 v174, v180, v181
    v_cvt_pk_bf16_f32 v175, v182, v183
    buffer_store_dwordx4 v[172:175], v1, s[24:27], s40 offen offset:1024 sc1
    s_branch K2_ret0
K2_burst1:
    s_cmp_ge_u32 s32, 5
    s_cbranch_scc1 K2_late1
    buffer_load_dwordx4 v1, s[24:27], s28 offen offset:0 lds
    buffer_load_dwordx4 v1, s[24:27], s28 offen offset:1024 lds
    buffer_load_dwordx4 v1, s[24:27], s28 offen offset:2048 lds
    buffer_load_dwordx4 v1, s[24:27], s28 offen offset:3072 lds
    s_add_u32 s54, s54, 4
    s_branch K2_ret1
K2_late1:
    s_cmp_eq_u32 s32, 6
    s_cbranch_scc1 K2_blkZ1
    s_cmp_eq_u32 s32, 7
    s_cbranch_scc1 K2_blkF1
    v_add_u32 v3, 131072, v1
    ds_read_b128 v[136:139], v3 offset:0
    ds_read_b128 v[140:143], v3 offset:1024
    ds_read_b128 v[144:147], v3 offset:2048
    ds_read_b128 v[148:151], v3 offset:3072
    v_add_u32 v3, 135168, v2
    ds_read_b32 v152, v3 offset:0
    ds_read_b32 v153, v3 offset:256
    ds_read_b32 v154, v3 offset:512
    ds_read_b32 v155, v3 offset:768
    ds_read_b32 v156, v3 offset:1024
    ds_read_b32 v157, v3 offset:1280
    ds_read_b32 v158, v3 offset:1536
    ds_read_b32 v159, v3 offset:1792
    s_add_u32 s54, s54, 4
    v_lshlrev_b32 v3, 5, v0
    buffer_load_dword v207, v3, s[48:51], s52 offen
    s_branch K2_ret1
K2_blkZ1:
    v_cvt_pk_bf16_f32 v152, v152, v153
    v_cvt_pk_bf16_f32 v153, v154, v155
    v_cvt_pk_bf16_f32 v154, v156, v157
    v_cvt_pk_bf16_f32 v155, v158, v159
    v_mfma_f32_32x32x16_bf16 v[184:199], v[144:147], v[120:123], 0
    v_cvt_pk_bf16_f32 v156, v160, v161
    v_cvt_pk_bf16_f32 v157, v162, v163
    v_cvt_pk_bf16_f32 v158, v164, v165
    v_cvt_pk_bf16_f32 v159, v166, v167
    v_cvt_pk_bf16_f32 v160, v168, v169
    v_cvt_pk_bf16_f32 v161, v170, v171
    v_cvt_pk_bf16_f32 v162, v172, v173
    v_cvt_pk_bf16_f32 v163, v174, v175
    v_mfma_f32_32x32x16_bf16 v[184:199], v[148:151], v[124:127], v[184:199]
    v_cvt_pk_bf16_f32 v164, v176, v177
    v_cvt_pk_bf16_f32 v165, v178, v179
    v_cvt_pk_bf16_f32 v166, v180, v181
    v_cvt_pk_bf16_f32 v167, v182, v183
    v_mfma_f32_32x32x16_bf16 v[168:183], v[136:139], v[112:115], 0
    v_cndmask_b32 v152, v108, v152, s[66:67]
    v_cndmask_b32 v153, v108, v153, s[66:67]
    v_cndmask_b32 v154, v108, v154, s[66:67]
    v_cndmask_b32 v155, v108, v155, s[66:67]
    v_cndmask_b32 v160, v108, v160, s[66:67]
    v_cndmask_b32 v161, v108, v161, s[66:67]
    v_cndmask_b32 v162, v108, v162, s[66:67]
    v_cndmask_b32 v163, v108, v163, s[66:67]
    v_mfma_f32_32x32x16_bf16 v[168:183], v[140:143], v[116:119], v[168:183]
    v_cndmask_b32 v156, v108, v156, s[66:67]
    v_cndmask_b32 v157, v108, v157, s[66:67]
    v_cndmask_b32 v158, v108, v158, s[66:67]
    v_cndmask_b32 v159, v108, v159, s[66:67]
    v_cndmask_b32 v164, v108, v164, s[66:67]
    v_cndmask_b32 v165, v108, v165, s[66:67]
    v_cndmask_b32 v166, v108, v166, s[66:67]
    v_cndmask_b32 v167, v108, v167, s[66:67]
    v_mfma_f32_16x16x32_bf16 v[200:203], v[152:155], v[112:115], 0
    v_mfma_f32_16x16x32_bf16 v[204:207], v[160:163], v[120:123], 0
    v_mfma_f32_16x16x32_bf16 v[200:203], v[156:159], v[116:119], v[200:203]
    v_mfma_f32_16x16x32_bf16 v[204:207], v[164:167], v[124:127], v[204:207]
    s_branch K2_ret1
K2_blkF1:
    v_rcp_f32 v200, v200
    v_rcp_f32 v204, v204
    v_mov_b32 v208, 0x358637bd
    v_fmac_f32 v208, v200, v201
    v_fmac_f32 v208, v204, v205
    v_rcp_f32 v208, v208
    s_nop 0
    v_mul_f32 v200, v200, v208
    v_mul_f32 v204, v204, v208
    v_pk_mul_f32 v[168:169], v[168:169], v[200:201] op_sel_hi:[1,0]
    v_pk_mul_f32 v[170:171], v[170:171], v[200:201] op_sel_hi:[1,0]
    v_pk_mul_f32 v[172:173], v[172:173], v[200:201] op_sel_hi:[1,0]
    v_pk_mul_f32 v[174:175], v[174:175], v[200:201] op_sel_hi:[1,0]
    v_pk_fma_f32 v[168:169], v[184:185], v[204:205], v[168:169] op_sel_hi:[1,0,1]
    v_pk_fma_f32 v[170:171], v[186:187], v[204:205], v[170:171] op_sel_hi:[1,0,1]
    v_pk_fma_f32 v[172:173], v[188:189], v[204:205], v[172:173] op_sel_hi:[1,0,1]
    v_pk_fma_f32 v[174:175], v[190:191], v[204:205], v[174:175] op_sel_hi:[1,0,1]
    v_cvt_pk_bf16_f32 v168, v168, v169
    v_cvt_pk_bf16_f32 v169, v170, v171
    v_cvt_pk_bf16_f32 v170, v172, v173
    v_cvt_pk_bf16_f32 v171, v174, v175
    buffer_store_dwordx4 v[168:171], v1, s[24:27], s40 offen offset:0 sc1
    v_pk_mul_f32 v[176:177], v[176:177], v[200:201] op_sel_hi:[1,0]
    v_pk_mul_f32 v[178:179], v[178:179], v[200:201] op_sel_hi:[1,0]
    v_pk_mul_f32 v[180:181], v[180:181], v[200:201] op_sel_hi:[1,0]
    v_pk_mul_f32 v[182:183], v[182:183], v[200:201] op_sel_hi:[1,0]
    v_pk_fma_f32 v[176:177], v[192:193], v[204:205], v[176:177] op_sel_hi:[1,0,1]
    v_pk_fma_f32 v[178:179], v[194:195], v[204:205], v[178:179] op_sel_hi:[1,0,1]
    v_pk_fma_f32 v[180:181], v[196:197], v[204:205], v[180:181] op_sel_hi:[1,0,1]
    v_pk_fma_f32 v[182:183], v[198:199], v[204:205], v[182:183] op_sel_hi:[1,0,1]
    v_cvt_pk_bf16_f32 v172, v176, v177
    v_cvt_pk_bf16_f32 v173, v178, v179
    v_cvt_pk_bf16_f32 v174, v180, v181
    v_cvt_pk_bf16_f32 v175, v182, v183
    buffer_store_dwordx4 v[172:175], v1, s[24:27], s40 offen offset:1024 sc1
    s_branch K2_ret1
K2_burst2:
    s_cmp_ge_u32 s32, 5
    s_cbranch_scc1 K2_late2
    buffer_load_dwordx4 v1, s[24:27], s28 offen offset:0 lds
    buffer_load_dwordx4 v1, s[24:27], s28 offen offset:1024 lds
    buffer_load_dwordx4 v1, s[24:27], s28 offen offset:2048 lds
    buffer_load_dwordx4 v1, s[24:27], s28 offen offset:3072 lds
    s_add_u32 s54, s54, 4
    s_branch K2_ret2
K2_late2:
    s_cmp_eq_u32 s32, 6
    s_cbranch_scc1 K2_blkZ2
    s_cmp_eq_u32 s32, 7
    s_cbranch_scc1 K2_blkF2
    v_add_u32 v3, 131072, v1
    ds_read_b128 v[136:139], v3 offset:0
    ds_read_b128 v[140:143], v3 offset:1024
    ds_read_b128 v[144:147], v3 offset:2048
    ds_read_b128 v[148:151], v3 offset:3072
    v_add_u32 v3, 135168, v2
    ds_read_b32 v152, v3 offset:0
    ds_read_b32 v153, v3 offset:256
    ds_read_b32 v154, v3 offset:512
    ds_read_b32 v155, v3 offset:768
    ds_read_b32 v156, v3 offset:1024
    ds_read_b32 v157, v3 offset:1280
    ds_read_b32 v158, v3 offset:1536
    ds_read_b32 v159, v3 offset:1792
    s_add_u32 s54, s54, 4
    v_lshlrev_b32 v3, 5, v0
    buffer_load_dword v207, v3, s[48:51], s52 offen
    s_branch K2_ret2
K2_blkZ2:
    v_cvt_pk_bf16_f32 v152, v152, v153
    v_cvt_pk_bf16_f32 v153, v154, v155
    v_cvt_pk_bf16_f32 v154, v156, v157
    v_cvt_pk_bf16_f32 v155, v158, v159
    v_mfma_f32_32x32x16_bf16 v[184:199], v[144:147], v[120:123], 0
    v_cvt_pk_bf16_f32 v156, v160, v161
    v_cvt_pk_bf16_f32 v157, v162, v163
    v_cvt_pk_bf16_f32 v158, v164, v165
    v_cvt_pk_bf16_f32 v159, v166, v167
    v_cvt_pk_bf16_f32 v160, v168, v169
    v_cvt_pk_bf16_f32 v161, v170, v171
    v_cvt_pk_bf16_f32 v162, v172, v173
    v_cvt_pk_bf16_f32 v163, v174, v175
    v_mfma_f32_32x32x16_bf16 v[184:199], v[148:151], v[124:127], v[184:199]
    v_cvt_pk_bf16_f32 v164, v176, v177
    v_cvt_pk_bf16_f32 v165, v178, v179
    v_cvt_pk_bf16_f32 v166, v180, v181
    v_cvt_pk_bf16_f32 v167, v182, v183
    v_mfma_f32_32x32x16_bf16 v[168:183], v[136:139], v[112:115], 0
    v_cndmask_b32 v152, v108, v152, s[66:67]
    v_cndmask_b32 v153, v108, v153, s[66:67]
    v_cndmask_b32 v154, v108, v154, s[66:67]
    v_cndmask_b32 v155, v108, v155, s[66:67]
    v_cndmask_b32 v160, v108, v160, s[66:67]
    v_cndmask_b32 v161, v108, v161, s[66:67]
    v_cndmask_b32 v162, v108, v162, s[66:67]
    v_cndmask_b32 v163, v108, v163, s[66:67]
    v_mfma_f32_32x32x16_bf16 v[168:183], v[140:143], v[116:119], v[168:183]
    v_cndmask_b32 v156, v108, v156, s[66:67]
    v_cndmask_b32 v157, v108, v157, s[66:67]
    v_cndmask_b32 v158, v108, v158, s[66:67]
    v_cndmask_b32 v159, v108, v159, s[66:67]
    v_cndmask_b32 v164, v108, v164, s[66:67]
    v_cndmask_b32 v165, v108, v165, s[66:67]
    v_cndmask_b32 v166, v108, v166, s[66:67]
    v_cndmask_b32 v167, v108, v167, s[66:67]
    v_mfma_f32_16x16x32_bf16 v[200:203], v[152:155], v[112:115], 0
    v_mfma_f32_16x16x32_bf16 v[204:207], v[160:163], v[120:123], 0
    v_mfma_f32_16x16x32_bf16 v[200:203], v[156:159], v[116:119], v[200:203]
    v_mfma_f32_16x16x32_bf16 v[204:207], v[164:167], v[124:127], v[204:207]
    s_branch K2_ret2
K2_blkF2:
    v_rcp_f32 v200, v200
    v_rcp_f32 v204, v204
    v_mov_b32 v208, 0x358637bd
    v_fmac_f32 v208, v200, v201
    v_fmac_f32 v208, v204, v205
    v_rcp_f32 v208, v208
    s_nop 0
    v_mul_f32 v200, v200, v208
    v_mul_f32 v204, v204, v208
    v_pk_mul_f32 v[168:169], v[168:169], v[200:201] op_sel_hi:[1,0]
    v_pk_mul_f32 v[170:171], v[170:171], v[200:201] op_sel_hi:[1,0]
    v_pk_mul_f32 v[172:173], v[172:173], v[200:201] op_sel_hi:[1,0]
    v_pk_mul_f32 v[174:175], v[174:175], v[200:201] op_sel_hi:[1,0]
    v_pk_fma_f32 v[168:169], v[184:185], v[204:205], v[168:169] op_sel_hi:[1,0,1]
    v_pk_fma_f32 v[170:171], v[186:187], v[204:205], v[170:171] op_sel_hi:[1,0,1]
    v_pk_fma_f32 v[172:173], v[188:189], v[204:205], v[172:173] op_sel_hi:[1,0,1]
    v_pk_fma_f32 v[174:175], v[190:191], v[204:205], v[174:175] op_sel_hi:[1,0,1]
    v_cvt_pk_bf16_f32 v168, v168, v169
    v_cvt_pk_bf16_f32 v169, v170, v171
    v_cvt_pk_bf16_f32 v170, v172, v173
    v_cvt_pk_bf16_f32 v171, v174, v175
    buffer_store_dwordx4 v[168:171], v1, s[24:27], s40 offen offset:0 sc1
    v_pk_mul_f32 v[176:177], v[176:177], v[200:201] op_sel_hi:[1,0]
    v_pk_mul_f32 v[178:179], v[178:179], v[200:201] op_sel_hi:[1,0]
    v_pk_mul_f32 v[180:181], v[180:181], v[200:201] op_sel_hi:[1,0]
    v_pk_mul_f32 v[182:183], v[182:183], v[200:201] op_sel_hi:[1,0]
    v_pk_fma_f32 v[176:177], v[192:193], v[204:205], v[176:177] op_sel_hi:[1,0,1]
    v_pk_fma_f32 v[178:179], v[194:195], v[204:205], v[178:179] op_sel_hi:[1,0,1]
    v_pk_fma_f32 v[180:181], v[196:197], v[204:205], v[180:181] op_sel_hi:[1,0,1]
    v_pk_fma_f32 v[182:183], v[198:199], v[204:205], v[182:183] op_sel_hi:[1,0,1]
    v_cvt_pk_bf16_f32 v172, v176, v177
    v_cvt_pk_bf16_f32 v173, v178, v179
    v_cvt_pk_bf16_f32 v174, v180, v181
    v_cvt_pk_bf16_f32 v175, v182, v183
    buffer_store_dwordx4 v[172:175], v1, s[24:27], s40 offen offset:1024 sc1
    s_branch K2_ret2
K2_burst3:
    s_cmp_ge_u32 s32, 5
    s_cbranch_scc1 K2_late3
    buffer_load_dwordx4 v1, s[24:27], s28 offen offset:0 lds
    buffer_load_dwordx4 v1, s[24:27], s28 offen offset:1024 lds
    buffer_load_dwordx4 v1, s[24:27], s28 offen offset:2048 lds
    buffer_load_dwordx4 v1, s[24:27], s28 offen offset:3072 lds
    s_add_u32 s54, s54, 4
    s_branch K2_ret3
K2_late3:
    s_cmp_eq_u32 s32, 6
    s_cbranch_scc1 K2_blkZ3
    s_cmp_eq_u32 s32, 7
    s_cbranch_scc1 K2_blkF3
    v_add_u32 v3, 131072, v1
    ds_read_b128 v[136:139], v3 offset:0
    ds_read_b128 v[140:143], v3 offset:1024
    ds_read_b128 v[144:147], v3 offset:2048
    ds_read_b128 v[148:151], v3 offset:3072
    v_add_u32 v3, 135168, v2
    ds_read_b32 v152, v3 offset:0
    ds_read_b32 v153, v3 offset:256
    ds_read_b32 v154, v3 offset:512
    ds_read_b32 v155, v3 offset:768
    ds_read_b32 v156, v3 offset:1024
    ds_read_b32 v157, v3 offset:1280
    ds_read_b32 v158, v3 offset:1536
    ds_read_b32 v159, v3 offset:1792
    s_add_u32 s54, s54, 4
    v_lshlrev_b32 v3, 5, v0
    buffer_load_dword v207, v3, s[48:51], s52 offen
    s_branch K2_ret3
K2_blkZ3:
    v_cvt_pk_bf16_f32 v152, v152, v153
    v_cvt_pk_bf16_f32 v153, v154, v155
    v_cvt_pk_bf16_f32 v154, v156, v157
    v_cvt_pk_bf16_f32 v155, v158, v159
    v_mfma_f32_32x32x16_bf16 v[184:199], v[144:147], v[120:123], 0
    v_cvt_pk_bf16_f32 v156, v160, v161
    v_cvt_pk_bf16_f32 v157, v162, v163
    v_cvt_pk_bf16_f32 v158, v164, v165
    v_cvt_pk_bf16_f32 v159, v166, v167
    v_cvt_pk_bf16_f32 v160, v168, v169
    v_cvt_pk_bf16_f32 v161, v170, v171
    v_cvt_pk_bf16_f32 v162, v172, v173
    v_cvt_pk_bf16_f32 v163, v174, v175
    v_mfma_f32_32x32x16_bf16 v[184:199], v[148:151], v[124:127], v[184:199]
    v_cvt_pk_bf16_f32 v164, v176, v177
    v_cvt_pk_bf16_f32 v165, v178, v179
    v_cvt_pk_bf16_f32 v166, v180, v181
    v_cvt_pk_bf16_f32 v167, v182, v183
    v_mfma_f32_32x32x16_bf16 v[168:183], v[136:139], v[112:115], 0
    v_cndmask_b32 v152, v108, v152, s[66:67]
    v_cndmask_b32 v153, v108, v153, s[66:67]
    v_cndmask_b32 v154, v108, v154, s[66:67]
    v_cndmask_b32 v155, v108, v155, s[66:67]
    v_cndmask_b32 v160, v108, v160, s[66:67]
    v_cndmask_b32 v161, v108, v161, s[66:67]
    v_cndmask_b32 v162, v108, v162, s[66:67]
    v_cndmask_b32 v163, v108, v163, s[66:67]
    v_mfma_f32_32x32x16_bf16 v[168:183], v[140:143], v[116:119], v[168:183]
    v_cndmask_b32 v156, v108, v156, s[66:67]
    v_cndmask_b32 v157, v108, v157, s[66:67]
    v_cndmask_b32 v158, v108, v158, s[66:67]
    v_cndmask_b32 v159, v108, v159, s[66:67]
    v_cndmask_b32 v164, v108, v164, s[66:67]
    v_cndmask_b32 v165, v108, v165, s[66:67]
    v_cndmask_b32 v166, v108, v166, s[66:67]
    v_cndmask_b32 v167, v108, v167, s[66:67]
    v_mfma_f32_16x16x32_bf16 v[200:203], v[152:155], v[112:115], 0
    v_mfma_f32_16x16x32_bf16 v[204:207], v[160:163], v[120:123], 0
    v_mfma_f32_16x16x32_bf16 v[200:203], v[156:159], v[116:119], v[200:203]
    v_mfma_f32_16x16x32_bf16 v[204:207], v[164:167], v[124:127], v[204:207]
    s_branch K2_ret3
K2_blkF3:
    v_rcp_f32 v200, v200
    v_rcp_f32 v204, v204
    v_mov_b32 v208, 0x358637bd
    v_fmac_f32 v208, v200, v201
    v_fmac_f32 v208, v204, v205
    v_rcp_f32 v208, v208
    s_nop 0
    v_mul_f32 v200, v200, v208
    v_mul_f32 v204, v204, v208
    v_pk_mul_f32 v[168:169], v[168:169], v[200:201] op_sel_hi:[1,0]
    v_pk_mul_f32 v[170:171], v[170:171], v[200:201] op_sel_hi:[1,0]
    v_pk_mul_f32 v[172:173], v[172:173], v[200:201] op_sel_hi:[1,0]
    v_pk_mul_f32 v[174:175], v[174:175], v[200:201] op_sel_hi:[1,0]
    v_pk_fma_f32 v[168:169], v[184:185], v[204:205], v[168:169] op_sel_hi:[1,0,1]
    v_pk_fma_f32 v[170:171], v[186:187], v[204:205], v[170:171] op_sel_hi:[1,0,1]
    v_pk_fma_f32 v[172:173], v[188:189], v[204:205], v[172:173] op_sel_hi:[1,0,1]
    v_pk_fma_f32 v[174:175], v[190:191], v[204:205], v[174:175] op_sel_hi:[1,0,1]
    v_cvt_pk_bf16_f32 v168, v168, v169
    v_cvt_pk_bf16_f32 v169, v170, v171
    v_cvt_pk_bf16_f32 v170, v172, v173
    v_cvt_pk_bf16_f32 v171, v174, v175
    buffer_store_dwordx4 v[168:171], v1, s[24:27], s40 offen offset:0 sc1
    v_pk_mul_f32 v[176:177], v[176:177], v[200:201] op_sel_hi:[1,0]
    v_pk_mul_f32 v[178:179], v[178:179], v[200:201] op_sel_hi:[1,0]
    v_pk_mul_f32 v[180:181], v[180:181], v[200:201] op_sel_hi:[1,0]
    v_pk_mul_f32 v[182:183], v[182:183], v[200:201] op_sel_hi:[1,0]
    v_pk_fma_f32 v[176:177], v[192:193], v[204:205], v[176:177] op_sel_hi:[1,0,1]
    v_pk_fma_f32 v[178:179], v[194:195], v[204:205], v[178:179] op_sel_hi:[1,0,1]
    v_pk_fma_f32 v[180:181], v[196:197], v[204:205], v[180:181] op_sel_hi:[1,0,1]
    v_pk_fma_f32 v[182:183], v[198:199], v[204:205], v[182:183] op_sel_hi:[1,0,1]
    v_cvt_pk_bf16_f32 v172, v176, v177
    v_cvt_pk_bf16_f32 v173, v178, v179
    v_cvt_pk_bf16_f32 v174, v180, v181
    v_cvt_pk_bf16_f32 v175, v182, v183
    buffer_store_dwordx4 v[172:175], v1, s[24:27], s40 offen offset:1024 sc1
    s_branch K2_ret3
K2_burst4:
    s_cmp_eq_u32 s32, 5
    s_cbranch_scc1 K2_burstZ4
    s_waitcnt vmcnt(4)
    v_pk_add_f32 v[128:129], v[128:129], v[112:113]
    v_pk_add_f32 v[130:131], v[130:131], v[114:115]
    buffer_load_dwordx4 v[112:115], v1, s[24:27], s68 offen
    s_add_u32 s68, s68, s69
    v_pk_add_f32 v[128:129], v[128:129], v[116:117]
    v_pk_add_f32 v[130:131], v[130:131], v[118:119]
    buffer_load_dwordx4 v[116:119], v1, s[24:27], s68 offen
    s_add_u32 s68, s68, s69
    v_pk_add_f32 v[128:129], v[128:129], v[120:121]
    v_pk_add_f32 v[130:131], v[130:131], v[122:123]
    buffer_load_dwordx4 v[120:123], v1, s[24:27], s68 offen
    s_add_u32 s68, s68, s69
    v_pk_add_f32 v[128:129], v[128:129], v[124:125]
    v_pk_add_f32 v[130:131], v[130:131], v[126:127]
    buffer_load_dwordx4 v[124:127], v1, s[24:27], s68 offen
    s_add_u32 s68, s68, s69
    s_cbranch_vccz K2_ret4
    v_permlane32_swap_b32 v132, v134
    v_permlane32_swap_b32 v133, v135
    v_cvt_pk_bf16_f32 v128, v128, v129
    v_cvt_pk_bf16_f32 v129, v130, v131
    v_add_f32 v132, v132, v134
    v_add_f32 v133, v133, v135
    v_add_u32 v3, s53, v1
    ds_write_b64 v3, v[128:129]
    v_permlane16_swap_b32 v132, v133
    v_add_f32 v132, v132, v133
    ds_write_b32 v6, v132
    s_branch K2_ret4
K2_burstZ4:
    v_add_f32 v152, v152, v153
    v_add_f32 v154, v154, v155
    v_add_f32 v156, v156, v157
    v_add_f32 v158, v158, v159
    v_add_f32 v152, v152, v154
    v_add_f32 v156, v156, v158
    v_add_u32 v3, 137216, v2
    v_add_f32 v152, v152, v156
    ds_write_b32 v3, v152
    v_lshlrev_b32 v3, 4, v7
    v_add_u32 v3, 137216, v3
    ds_read_b128 v[152:155], v3 offset:0
    ds_read_b128 v[156:159], v3 offset:32
    ds_read_b128 v[160:163], v3 offset:64
    ds_read_b128 v[164:167], v3 offset:96
    ds_read_b128 v[168:171], v3 offset:128
    ds_read_b128 v[172:175], v3 offset:160
    ds_read_b128 v[176:179], v3 offset:192
    ds_read_b128 v[180:183], v3 offset:224
    s_branch K2_ret4
K2_burst5:
    s_cmp_eq_u32 s32, 5
    s_cbranch_scc1 K2_burstZ5
    s_waitcnt vmcnt(4)
    v_pk_add_f32 v[128:129], v[128:129], v[112:113]
    v_pk_add_f32 v[130:131], v[130:131], v[114:115]
    buffer_load_dwordx4 v[112:115], v1, s[24:27], s68 offen
    s_add_u32 s68, s68, s69
    v_pk_add_f32 v[128:129], v[128:129], v[116:117]
    v_pk_add_f32 v[130:131], v[130:131], v[118:119]
    buffer_load_dwordx4 v[116:119], v1, s[24:27], s68 offen
    s_add_u32 s68, s68, s69
    v_pk_add_f32 v[128:129], v[128:129], v[120:121]
    v_pk_add_f32 v[130:131], v[130:131], v[122:123]
    buffer_load_dwordx4 v[120:123], v1, s[24:27], s68 offen
    s_add_u32 s68, s68, s69
    v_pk_add_f32 v[128:129], v[128:129], v[124:125]
    v_pk_add_f32 v[130:131], v[130:131], v[126:127]
    buffer_load_dwordx4 v[124:127], v1, s[24:27], s68 offen
    s_add_u32 s68, s68, s69
    s_cbranch_vccz K2_ret5
    v_permlane32_swap_b32 v132, v134
    v_permlane32_swap_b32 v133, v135
    v_cvt_pk_bf16_f32 v128, v128, v129
    v_cvt_pk_bf16_f32 v129, v130, v131
    v_add_f32 v132, v132, v134
    v_add_f32 v133, v133, v135
    v_add_u32 v3, s53, v1
    ds_write_b64 v3, v[128:129]
    v_permlane16_swap_b32 v132, v133
    v_add_f32 v132, v132, v133
    ds_write_b32 v6, v132
    s_branch K2_ret5
K2_burstZ5:
    v_add_f32 v152, v152, v153
    v_add_f32 v154, v154, v155
    v_add_f32 v156, v156, v157
    v_add_f32 v158, v158, v159
    v_add_f32 v152, v152, v154
    v_add_f32 v156, v156, v158
    v_add_u32 v3, 137216, v2
    v_add_f32 v152, v152, v156
    ds_write_b32 v3, v152
    v_lshlrev_b32 v3, 4, v7
    v_add_u32 v3, 137216, v3
    ds_read_b128 v[152:155], v3 offset:0
    ds_read_b128 v[156:159], v3 offset:32
    ds_read_b128 v[160:163], v3 offset:64
    ds_read_b128 v[164:167], v3 offset:96
    ds_read_b128 v[168:171], v3 offset:128
    ds_read_b128 v[172:175], v3 offset:160
    ds_read_b128 v[176:179], v3 offset:192
    ds_read_b128 v[180:183], v3 offset:224
    s_branch K2_ret5
K2_burst6:
    s_cmp_eq_u32 s32, 5
    s_cbranch_scc1 K2_burstZ6
    s_waitcnt vmcnt(4)
    v_pk_add_f32 v[128:129], v[128:129], v[112:113]
    v_pk_add_f32 v[130:131], v[130:131], v[114:115]
    buffer_load_dwordx4 v[112:115], v1, s[24:27], s68 offen
    s_add_u32 s68, s68, s69
    v_pk_add_f32 v[128:129], v[128:129], v[116:117]
    v_pk_add_f32 v[130:131], v[130:131], v[118:119]
    buffer_load_dwordx4 v[116:119], v1, s[24:27], s68 offen
    s_add_u32 s68, s68, s69
    v_pk_add_f32 v[128:129], v[128:129], v[120:121]
    v_pk_add_f32 v[130:131], v[130:131], v[122:123]
    buffer_load_dwordx4 v[120:123], v1, s[24:27], s68 offen
    s_add_u32 s68, s68, s69
    v_pk_add_f32 v[128:129], v[128:129], v[124:125]
    v_pk_add_f32 v[130:131], v[130:131], v[126:127]
    buffer_load_dwordx4 v[124:127], v1, s[24:27], s68 offen
    s_add_u32 s68, s68, s69
    s_cbranch_vccz K2_ret6
    v_permlane32_swap_b32 v132, v134
    v_permlane32_swap_b32 v133, v135
    v_cvt_pk_bf16_f32 v128, v128, v129
    v_cvt_pk_bf16_f32 v129, v130, v131
    v_add_f32 v132, v132, v134
    v_add_f32 v133, v133, v135
    v_add_u32 v3, s53, v1
    ds_write_b64 v3, v[128:129]
    v_permlane16_swap_b32 v132, v133
    v_add_f32 v132, v132, v133
    ds_write_b32 v6, v132
    s_branch K2_ret6
K2_burstZ6:
    v_add_f32 v152, v152, v153
    v_add_f32 v154, v154, v155
    v_add_f32 v156, v156, v157
    v_add_f32 v158, v158, v159
    v_add_f32 v152, v152, v154
    v_add_f32 v156, v156, v158
    v_add_u32 v3, 137216, v2
    v_add_f32 v152, v152, v156
    ds_write_b32 v3, v152
    v_lshlrev_b32 v3, 4, v7
    v_add_u32 v3, 137216, v3
    ds_read_b128 v[152:155], v3 offset:0
    ds_read_b128 v[156:159], v3 offset:32
    ds_read_b128 v[160:163], v3 offset:64
    ds_read_b128 v[164:167], v3 offset:96
    ds_read_b128 v[168:171], v3 offset:128
    ds_read_b128 v[172:175], v3 offset:160
    ds_read_b128 v[176:179], v3 offset:192
    ds_read_b128 v[180:183], v3 offset:224
    s_branch K2_ret6
K2_burst7:
    s_cmp_eq_u32 s32, 5
    s_cbranch_scc1 K2_burstZ7
    s_waitcnt vmcnt(4)
    v_pk_add_f32 v[128:129], v[128:129], v[112:113]
    v_pk_add_f32 v[130:131], v[130:131], v[114:115]
    buffer_load_dwordx4 v[112:115], v1, s[24:27], s68 offen
    s_add_u32 s68, s68, s69
    v_pk_add_f32 v[128:129], v[128:129], v[116:117]
    v_pk_add_f32 v[130:131], v[130:131], v[118:119]
    buffer_load_dwordx4 v[116:119], v1, s[24:27], s68 offen
    s_add_u32 s68, s68, s69
    v_pk_add_f32 v[128:129], v[128:129], v[120:121]
    v_pk_add_f32 v[130:131], v[130:131], v[122:123]
    buffer_load_dwordx4 v[120:123], v1, s[24:27], s68 offen
    s_add_u32 s68, s68, s69
    v_pk_add_f32 v[128:129], v[128:129], v[124:125]
    v_pk_add_f32 v[130:131], v[130:131], v[126:127]
    buffer_load_dwordx4 v[124:127], v1, s[24:27], s68 offen
    s_add_u32 s68, s68, s69
    s_cbranch_vccz K2_ret7
    v_permlane32_swap_b32 v132, v134
    v_permlane32_swap_b32 v133, v135
    v_cvt_pk_bf16_f32 v128, v128, v129
    v_cvt_pk_bf16_f32 v129, v130, v131
    v_add_f32 v132, v132, v134
    v_add_f32 v133, v133, v135
    v_add_u32 v3, s53, v1
    ds_write_b64 v3, v[128:129]
    v_permlane16_swap_b32 v132, v133
    v_add_f32 v132, v132, v133
    ds_write_b32 v6, v132
    s_branch K2_ret7
K2_burstZ7:
    v_add_f32 v152, v152, v153
    v_add_f32 v154, v154, v155
    v_add_f32 v156, v156, v157
    v_add_f32 v158, v158, v159
    v_add_f32 v152, v152, v154
    v_add_f32 v156, v156, v158
    v_add_u32 v3, 137216, v2
    v_add_f32 v152, v152, v156
    ds_write_b32 v3, v152
    v_lshlrev_b32 v3, 4, v7
    v_add_u32 v3, 137216, v3
    ds_read_b128 v[152:155], v3 offset:0
    ds_read_b128 v[156:159], v3 offset:32
    ds_read_b128 v[160:163], v3 offset:64
    ds_read_b128 v[164:167], v3 offset:96
    ds_read_b128 v[168:171], v3 offset:128
    ds_read_b128 v[172:175], v3 offset:160
    ds_read_b128 v[176:179], v3 offset:192
    ds_read_b128 v[180:183], v3 offset:224
    s_branch K2_ret7
K2_fallback:
    s_waitcnt vmcnt(0) lgkmcnt(0)
    s_mov_b32 s28, 12582912
    v_mov_b32 v208, 0xff800000
K2_fb1:
    buffer_load_dwordx4 v[16:19], v1, s[24:27], s28 offen
    buffer_load_dwordx4 v[20:23], v1, s[24:27], s28 offen offset:1024
    s_add_u32 s28, s28, 4096
    s_waitcnt vmcnt(0)
    v_mfma_f32_32x32x16_bf16 v[32:47], v[16:19], v[8:11], 0
    v_mfma_f32_32x32x16_bf16 v[32:47], v[20:23], v[12:15], v[32:47]
    s_nop 11
    v_max3_f32 v208, v208, v32, v33
    v_max3_f32 v208, v208, v34, v35
    v_max3_f32 v208, v208, v36, v37
    v_max3_f32 v208, v208, v38, v39
    v_max3_f32 v208, v208, v40, v41
    v_max3_f32 v208, v208, v42, v43
    v_max3_f32 v208, v208, v44, v45
    v_max3_f32 v208, v208, v46, v47
    s_cmp_lt_u32 s28, 12845056
    s_cbranch_scc1 K2_fb1
    v_mov_b32 v209, v208
    s_nop 1
    v_permlane32_swap_b32 v208, v209
    v_max_f32 v208, v208, v209
    v_sub_f32 v64, 0, v208
    v_mov_b32 v88, 0
    v_sub_f32 v65, 0, v208
    v_mov_b32 v89, 0
    v_sub_f32 v66, 0, v208
    v_mov_b32 v90, 0
    v_sub_f32 v67, 0, v208
    v_mov_b32 v91, 0
    v_sub_f32 v68, 0, v208
    v_mov_b32 v92, 0
    v_sub_f32 v69, 0, v208
    v_mov_b32 v93, 0
    v_sub_f32 v70, 0, v208
    v_mov_b32 v94, 0
    v_sub_f32 v71, 0, v208
    v_mov_b32 v95, 0
    v_sub_f32 v72, 0, v208
    v_mov_b32 v96, 0
    v_sub_f32 v73, 0, v208
    v_mov_b32 v97, 0
    v_sub_f32 v74, 0, v208
    v_mov_b32 v98, 0
    v_sub_f32 v75, 0, v208
    v_mov_b32 v99, 0
    v_sub_f32 v76, 0, v208
    v_mov_b32 v100, 0
    v_sub_f32 v77, 0, v208
    v_mov_b32 v101, 0
    v_sub_f32 v78, 0, v208
    v_mov_b32 v102, 0
    v_sub_f32 v79, 0, v208
    v_mov_b32 v103, 0
    v_mov_b32 v104, 0
    v_mov_b32 v105, 0
    v_mov_b32 v106, 0
    v_mov_b32 v107, 0
    s_mov_b32 s28, 12582912
K2_fb2:
    buffer_load_dwordx4 v[16:19], v1, s[24:27], s28 offen offset:0
    buffer_load_dwordx4 v[20:23], v1, s[24:27], s28 offen offset:1024
    buffer_load_dwordx4 v[24:27], v1, s[24:27], s28 offen offset:2048
    buffer_load_dwordx4 v[28:31], v1, s[24:27], s28 offen offset:3072
    s_add_u32 s28, s28, 4096
    s_waitcnt vmcnt(0)
    v_mfma_f32_32x32x16_bf16 v[32:47], v[16:19], v[8:11], v[64:79]
    v_mfma_f32_32x32x16_bf16 v[32:47], v[20:23], v[12:15], v[32:47]
    s_nop 11
    v_exp_f32 v32, v32
    v_exp_f32 v33, v33
    v_exp_f32 v34, v34
    v_exp_f32 v35, v35
    v_exp_f32 v36, v36
    v_exp_f32 v37, v37
    v_exp_f32 v38, v38
    v_exp_f32 v39, v39
    v_exp_f32 v40, v40
    v_exp_f32 v41, v41
    v_exp_f32 v42, v42
    v_exp_f32 v43, v43
    v_exp_f32 v44, v44
    v_exp_f32 v45, v45
    v_exp_f32 v46, v46
    v_exp_f32 v47, v47
    v_smfmac_f32_32x32x32_bf16 v[88:103], v[24:27], v[32:39], v84
    s_nop 0
    v_smfmac_f32_32x32x32_bf16 v[88:103], v[28:31], v[40:47], v84
    v_smfmac_f32_16x16x64_bf16 v[104:107], v[80:83], v[32:39], v84
    v_smfmac_f32_16x16x64_bf16 v[104:107], v[80:83], v[40:47], v84
    s_cmp_lt_u32 s28, 12845056
    s_nop 7
    s_cbranch_scc1 K2_fb2
    s_nop 15
    v_rcp_f32 v208, v104
    s_nop 1
    s_branch K2_fin
K2_end:
    s_endpgm
.section .rodata,"a"
.p2align 6
.amdhsa_kernel k1_kernel
  .amdhsa_next_free_vgpr 192
  .amdhsa_next_free_sgpr 102
  .amdhsa_accum_offset 192
  .amdhsa_group_segment_fixed_size 0
  .amdhsa_kernarg_size 96
  .amdhsa_user_sgpr_count 2
  .amdhsa_user_sgpr_kernarg_segment_ptr 1
  .amdhsa_system_sgpr_workgroup_id_x 1
.end_amdhsa_kernel
.p2align 6
.amdhsa_kernel k2_kernel
  .amdhsa_next_free_vgpr 212
  .amdhsa_next_free_sgpr 102
  .amdhsa_accum_offset 212
  .amdhsa_group_segment_fixed_size 0
  .amdhsa_kernarg_size 96
  .amdhsa_user_sgpr_count 2
  .amdhsa_user_sgpr_kernarg_segment_ptr 1
  .amdhsa_system_sgpr_workgroup_id_x 1
.end_amdhsa_kernel
```
